```python
import torch

def _softmax(x, axis=-1):
    return torch.softmax(x, dim=axis)
def _gelu(x):
    return torch.nn.functional.gelu(x, approximate="tanh")
def _silu(x):
    return torch.nn.functional.silu(x)
def _sigmoid(x):
    return torch.sigmoid(x)
def _layernorm(x, axis=-1, eps=1e-5):
    m = x.mean(dim=axis, keepdim=True)
    v = x.var(dim=axis, keepdim=True, unbiased=False)
    return (x - m) / torch.sqrt(v + eps)
def _scatter_add(tgt, idx, src, axis=0):
    return tgt.clone().index_add_(axis, idx, src)
def _segment_sum(src, seg, n):
    out = torch.zeros((n,) + src.shape[1:], dtype=src.dtype)
    return out.index_add_(0, seg, src)
def _pad(x, pw):
    flat = tuple(v for pair in reversed(pw) for v in pair)
    return torch.nn.functional.pad(x, flat)

kernel_name = 'standalone__deep_cross_xdeepfm__recsys'

def setup_inputs():

    _w = (lambda a: (lambda t: t.to(torch.bfloat16) if t.is_floating_point() else t)(torch.as_tensor(a)))
    B, F, D, L = 4096, 26, 32, 3
    V = min(100000, 100000)
    Din = F * D
    return {
        "idx": _w((lambda lo, hi, *s: torch.randint(lo, hi, s))(0, V, B, F).to(torch.int64)),
        "table": _w((lambda *s: torch.randn(*s, dtype=torch.bfloat16) * 0.8)(V, D)),
        "ws_cin": _w((lambda *s: torch.randn(*s, dtype=torch.bfloat16) * 0.2)(L, F, F, F) * (1.0 / F)),
        "w_cin_out": _w((lambda *s: torch.randn(*s, dtype=torch.bfloat16) * 0.2)(L * F) * ((L * F) ** -0.5)),
        "w_dnn1": _w((lambda *s: torch.randn(*s, dtype=torch.bfloat16) * 0.8)(Din, Din) * (Din ** -0.5)),
        "b_dnn1": _w((lambda *s: torch.randn(*s, dtype=torch.bfloat16) * 1.6)(Din) * 0.1),
        "w_dnn2": _w((lambda *s: torch.randn(*s, dtype=torch.bfloat16) * 0.2)(Din) * (Din ** -0.5)),
        "b_out": _w((lambda *s: torch.randn(*s, dtype=torch.bfloat16) * 0.2)(1)),
    }

def reference(idx, table, ws_cin, w_cin_out, w_dnn1, b_dnn1, w_dnn2, b_out):
    x0 = table[idx]
    B = x0.shape[0]
    L = ws_cin.shape[0]
    xk = x0
    pooled = []
    for l in range(L):
        xk = torch.einsum('bid,bjd,hij->bhd', xk, x0, ws_cin[l])
        pooled.append(xk.sum(axis=-1))
    p_plus = torch.stack(pooled, axis=1).reshape(B, -1)
    logit_cin = p_plus @ w_cin_out
    h = x0.reshape(B, -1)
    h = _gelu(h @ w_dnn1 + b_dnn1)
    logit_dnn = h @ w_dnn2
    return logit_cin + logit_dnn + b_out
```

```asm
; @launch grid=(256,1,1) block=(512,1,1) lds=163840
.amdgcn_target "amdgcn-amd-amdhsa--gfx950"
.text
.globl standalone__deep_cross_xdeepfm__recsys_kernel
.p2align 8
.type standalone__deep_cross_xdeepfm__recsys_kernel,@function
standalone__deep_cross_xdeepfm__recsys_kernel:
    s_load_dwordx16 s[52:67], s[0:1], 0
    s_load_dwordx4 s[36:39], s[0:1], 64
    s_load_dwordx2 s[32:33], s[0:1], 80
    v_lshrrev_b32 v1, 6, v0
    v_and_b32 v0, 63, v0
    v_readfirstlane_b32 s42, v1
    s_cmp_ge_u32 s2, 0x100
    s_cbranch_scc1 L_end
    s_and_b32 s3, s2, 7
    s_lshr_b32 s43, s2, 6
    s_lshl3_add_u32 s43, s43, s3
    s_bfe_u32 s44, s2, 0x20004
    v_lshlrev_b32 v165, 4, v0
    v_lshlrev_b32 v160, 7, v0
    s_mov_b32 s6, 425984
    s_mov_b32 s7, 0x20000
    s_mov_b32 s14, 1384448
    s_mov_b32 s15, 0x20000
    s_bitcmp1_b32 s2, 3
    s_cbranch_scc1 L_cin
    s_lshl3_add_u32 s3, s43, s42
    s_mul_i32 s3, s3, 1664
    s_mul_i32 s47, s42, 1664
    s_add_u32 m0, s47, 150528
    s_lshr_b32 s51, s2, 4
    s_lshl3_add_u32 s51, s51, s42
    s_mul_i32 s51, s51, 2560
    s_waitcnt lgkmcnt(0)
    s_mov_b64 s[4:5], s[52:53]
    s_mov_b64 s[12:13], s[60:61]
    buffer_load_dwordx4 v165, s[4:7], s3 offen offset:0 lds
    s_mov_b32 exec_hi, 0xff
    buffer_load_dwordx4 v165, s[4:7], s3 offen offset:1024 lds
    s_mov_b64 s[16:17], s[56:57]
    s_mov_b32 s18, 105456
    s_mov_b32 s19, 0x20000
    s_lshr_b32 s3, s2, 4
    s_lshl3_add_u32 s3, s3, s42
    s_mul_i32 s3, s3, 384
    s_add_u32 s3, s3, 70272
    s_mov_b64 exec, 7
    buffer_load_dword v250, v160, s[16:19], s3 offen
    s_mov_b64 exec, 1048575
    buffer_load_dword v250, v160, s[12:15], s51 offen
    s_mov_b64 exec, -1
    s_branch L_dnn
L_cin:
    s_sub_u32 s47, s42, 4
    s_cbranch_scc1 L_pwave
    s_lshl3_add_u32 s3, s43, s44
    s_lshr_b32 s45, s47, 1
    s_lshl2_add_u32 s3, s45, s3
    s_and_b32 s51, s47, 1
    s_lshl1_add_u32 s3, s3, s51
    s_mul_i32 s3, s3, 832
    s_mul_i32 s51, s47, 832
    s_add_u32 m0, s51, 154112
    s_mov_b32 exec_hi, 0xfffff
    s_waitcnt lgkmcnt(0)
    s_mov_b64 s[4:5], s[52:53]
    buffer_load_dwordx4 v165, s[4:7], s3 offen lds
    s_getpc_b64 s[48:49]
L_pc3:
    s_lshr_b32 s51, s2, 4
    s_lshl2_add_u32 s51, s51, s47
    s_mul_i32 s51, s51, 640
    v_add_u32 v2, s51, v160
    v_min_u32 v2, gather_table-L_pc3+4092, v2
    s_mov_b64 exec, 31
    global_load_dword v250, v2, s[48:49]
    s_branch L_xwave
L_pwave:
    s_mov_b32 s22, 156
    s_mov_b32 s23, 0x20000
    s_mov_b32 s34, 305408
    s_mov_b32 s35, 0x20000
    s_mov_b32 s50, 0x40000
    v_lshlrev_b32 v162, 2, v0
    v_add_u32 v162, 163328, v162
    v_mov_b32 v163, 1
    s_mov_b32 s18, 105456
    s_mov_b32 s19, 0x20000
    s_lshr_b32 s45, s2, 6
    s_sub_u32 s45, s43, s45
    s_sub_u32 s45, s45, 1
    s_and_b32 s51, s2, 0x37
    s_sub_u32 s51, s51, 1
    s_cmp_lt_u32 s51, 7
    s_cselect_b32 s45, s45, 99
    s_getpc_b64 s[48:49]
L_pc:
    s_waitcnt lgkmcnt(0)
    s_mov_b64 s[16:17], s[56:57]
    s_mov_b64 s[12:13], s[60:61]
    s_mov_b64 s[20:21], s[58:59]
    s_load_dword s40, s[66:67], 0
    s_cmp_lt_u32 s44, 2
    s_cbranch_scc1 L_nomt
    s_lshl1_add_u32 s52, s43, s44
    s_lshl2_add_u32 s52, s52, s42
    s_mul_i32 s53, s52, 4224
    s_add_u32 s53, s53, 293888
    s_mov_b32 exec_hi, 0x1
    buffer_load_dword v250, v160, s[12:15], s53 offen
    s_mov_b64 exec, -1
L_nomt:
    s_cmp_ge_u32 s45, 26
    s_cbranch_scc1 L_cbar
    s_setprio 3
    s_mul_i32 s54, s45, 1664
    s_add_u32 s54, s54, 262144
    s_lshr_b32 s55, s45, 1
    s_lshl_b32 s55, s55, 2
    s_load_dword s56, s[20:21], s55
    v_and_b32 v2, 0x30, v0
    v_bfe_u32 v1, v0, 2, 2
    v_xor_b32 v3, 0, v1
    v_lshl_add_u32 v3, v3, 28, v2
    buffer_load_dwordx4 v[56:59], v3, s[20:23], 0 offen offset:104
    v_xor_b32 v3, 1, v1
    v_lshl_add_u32 v3, v3, 28, v2
    buffer_load_dwordx4 v[60:63], v3, s[20:23], 0 offen offset:104
    v_xor_b32 v3, 2, v1
    v_lshl_add_u32 v3, v3, 28, v2
    buffer_load_dwordx4 v[64:67], v3, s[20:23], 0 offen offset:104
    v_xor_b32 v3, 3, v1
    v_lshl_add_u32 v3, v3, 28, v2
    buffer_load_dwordx4 v[68:71], v3, s[20:23], 0 offen offset:104
    s_cmp_ge_u32 s42, 2
    s_cbranch_scc1 L_p23
    s_lshl_b32 s52, s42, 11
    s_add_u32 s52, s52, gather_table-L_pc
    v_lshl_add_u32 v1, v0, 5, s52
    global_load_dwordx4 v[32:35], v1, s[48:49]
    global_load_dwordx4 v[36:39], v1, s[48:49] offset:16
    s_cmp_lg_u32 s42, 0
    s_cbranch_scc1 L_p1
    v_lshrrev_b32 v3, 5, v0
    v_mul_u32_u24 v3, 0x2a40, v3
    v_and_b32 v2, 31, v0
    v_lshl_add_u32 v3, v2, 1, v3
    s_mul_i32 s52, s45, 52
    s_add_u32 s52, s52, 35152
    buffer_load_ushort v40, v3, s[16:19], s52 offen offset:0
    buffer_load_ushort v41, v3, s[16:19], s52 offen offset:1352
    buffer_load_ushort v42, v3, s[16:19], s52 offen offset:2704
    buffer_load_ushort v43, v3, s[16:19], s52 offen offset:4056
    s_add_u32 s52, s52, 5408
    buffer_load_ushort v44, v3, s[16:19], s52 offen offset:0
    buffer_load_ushort v45, v3, s[16:19], s52 offen offset:1352
    buffer_load_ushort v46, v3, s[16:19], s52 offen offset:2704
    buffer_load_ushort v47, v3, s[16:19], s52 offen offset:4056
    s_add_u32 s52, s52, 16224
    buffer_load_ushort v48, v3, s[16:19], s52 offen offset:0
    buffer_load_ushort v49, v3, s[16:19], s52 offen offset:1352
    buffer_load_ushort v50, v3, s[16:19], s52 offen offset:2704
    buffer_load_ushort v51, v3, s[16:19], s52 offen offset:4056
    s_add_u32 s52, s52, 5408
    buffer_load_ushort v52, v3, s[16:19], s52 offen offset:0
    buffer_load_ushort v53, v3, s[16:19], s52 offen offset:1352
    buffer_load_ushort v54, v3, s[16:19], s52 offen offset:2704
    buffer_load_ushort v55, v3, s[16:19], s52 offen offset:4056
    s_branch L_pz
L_p1:
    s_mul_i32 s52, s45, 1352
    s_mov_b32 m0, 151552
    s_nop 0
    buffer_load_dwordx4 v165, s[16:19], s52 offen offset:0 lds
    buffer_load_dwordx4 v165, s[16:19], s52 offen offset:1024 lds
    s_branch L_pz
L_p23:
    s_cmp_lg_u32 s42, 3
    s_cbranch_scc1 L_pz
    v_lshlrev_b32 v1, 2, v0
    buffer_load_dword v27, v1, s[20:23], 0 offen offset:52
    v_mov_b32 v4, -1
    v_mov_b32 v5, -1
    v_mov_b32 v6, -1
    v_mov_b32 v7, -1
    buffer_store_dwordx4 v[4:7], v165, s[32:35], s54 offen sc1
    s_mov_b32 exec_hi, 0xff
    buffer_store_dwordx4 v[4:7], v165, s[32:35], s54 offen offset:1024 sc1
    s_mov_b32 exec_hi, -1
L_pz:
    s_mul_i32 s52, s42, 9216
    s_add_u32 s53, s52, 70304
    s_add_u32 s52, s52, 108032
    s_add_u32 m0, s52, 0
    s_nop 0
    buffer_load_dwordx4 v165, s[16:19], s53 offen offset:0 lds
    buffer_load_dwordx4 v165, s[16:19], s53 offen offset:1024 lds
    buffer_load_dwordx4 v165, s[16:19], s53 offen offset:2048 lds
    buffer_load_dwordx4 v165, s[16:19], s53 offen offset:3072 lds
    s_add_u32 s53, s53, 0x1000
    s_add_u32 m0, s52, 4096
    s_nop 0
    buffer_load_dwordx4 v165, s[16:19], s53 offen offset:0 lds
    buffer_load_dwordx4 v165, s[16:19], s53 offen offset:1024 lds
    buffer_load_dwordx4 v165, s[16:19], s53 offen offset:2048 lds
    buffer_load_dwordx4 v165, s[16:19], s53 offen offset:3072 lds
    s_add_u32 s53, s53, 0x1000
    s_add_u32 m0, s52, 8192
    s_nop 0
    buffer_load_dwordx4 v165, s[16:19], s53 offen offset:0 lds
    v_mov_b32 v2, 0
    v_mov_b32 v3, 0
    s_lshl_b32 s52, s42, 9
    s_add_u32 s52, s52, 144896
    v_lshl_add_u32 v1, v0, 3, s52
    ds_write_b64 v1, v[2:3]
    v_add_u32 v1, -9728, v162
    ds_write_b32 v1, v2
L_cbar:
    v_mov_b32 v2, 0
    ds_write_b32 v162, v2
    s_waitcnt lgkmcnt(0)
    s_barrier
    s_cmp_lt_u32 s45, 26
    s_cbranch_scc1 L_prep
    s_branch L_setup
L_prep:
    s_cmp_lg_u32 s42, 2
    s_cbranch_scc1 L_nmb
    v_mov_b32 v4, -1
    v_mov_b32 v5, -1
    v_mov_b32 v6, -1
    v_mov_b32 v7, -1
    s_mul_i32 s52, s45, 10240
    s_min_u32 s52, s52, 251904
    buffer_store_dwordx4 v[4:7], v165, s[32:35], s52 offen offset:0 sc1
    buffer_store_dwordx4 v[4:7], v165, s[32:35], s52 offen offset:1024 sc1
    buffer_store_dwordx4 v[4:7], v165, s[32:35], s52 offen offset:2048 sc1
    buffer_store_dwordx4 v[4:7], v165, s[32:35], s52 offen offset:3072 sc1
    s_add_u32 s52, s52, 0x1000
    buffer_store_dwordx4 v[4:7], v165, s[32:35], s52 offen offset:0 sc1
    buffer_store_dwordx4 v[4:7], v165, s[32:35], s52 offen offset:1024 sc1
    buffer_store_dwordx4 v[4:7], v165, s[32:35], s52 offen offset:2048 sc1
    buffer_store_dwordx4 v[4:7], v165, s[32:35], s52 offen offset:3072 sc1
    s_add_u32 s52, s52, 0x1000
    buffer_store_dwordx4 v[4:7], v165, s[32:35], s52 offen offset:0 sc1
    buffer_store_dwordx4 v[4:7], v165, s[32:35], s52 offen offset:1024 sc1
    s_nop 0
L_nmb:
    s_lshl_b32 s55, s56, 16
    s_and_b32 s56, s56, 0xffff0000
    s_bitcmp1_b32 s45, 0
    s_cselect_b32 s55, s56, s55
    v_mov_b32 v1, 153728
    v_mov_b32 v2, s55
    ds_write_b32 v1, v2
    v_bfe_u32 v1, v0, 2, 2
    v_lshrrev_b32 v4, 4, v0
    v_lshl_add_u32 v4, v4, 3, v1
    v_add_u32 v5, 4, v4
    v_min_u32 v4, 25, v4
    v_min_u32 v5, 25, v5
    v_and_b32 v6, 3, v0
    s_mul_i32 s52, s42, 384
    s_add_u32 s52, s52, 108032
    v_lshl_add_u32 v6, v6, 3, s52
    s_movk_i32 s53, 1352
    v_mad_u32_u24 v2, v4, s53, v6
    v_mad_u32_u24 v3, v5, s53, v6
    s_mul_i32 s52, s42, 192
    s_movk_i32 s53, -1662
    v_mov_b32 v7, 153856
    v_add_u32 v4, s52, v0
    s_add_u32 s52, s52, 64
    v_mul_u32_u24 v5, 2521, v4
    v_lshrrev_b32 v5, 16, v5
    v_cmp_gt_u32 vcc, 0x2a4, v4
    v_lshlrev_b32 v4, 6, v4
    v_mad_i32_i24 v4, v5, s53, v4
    v_add_u32 v4, 144896, v4
    v_cndmask_b32 v8, v7, v4, vcc
    v_add_u32 v4, s52, v0
    s_add_u32 s52, s52, 64
    v_mul_u32_u24 v5, 2521, v4
    v_lshrrev_b32 v5, 16, v5
    v_cmp_gt_u32 vcc, 0x2a4, v4
    v_lshlrev_b32 v4, 6, v4
    v_mad_i32_i24 v4, v5, s53, v4
    v_add_u32 v4, 144896, v4
    v_cndmask_b32 v9, v7, v4, vcc
    v_add_u32 v4, s52, v0
    v_mul_u32_u24 v5, 2521, v4
    v_lshrrev_b32 v5, 16, v5
    v_cmp_gt_u32 vcc, 0x2a4, v4
    v_lshlrev_b32 v4, 6, v4
    v_mad_i32_i24 v4, v5, s53, v4
    v_add_u32 v4, 144896, v4
    v_cndmask_b32 v10, v7, v4, vcc
    v_and_b32 v5, 31, v0
    v_lshrrev_b32 v4, 5, v0
    v_lshlrev_b32 v6, 6, v5
    v_lshl_add_u32 v6, v4, 4, v6
    v_add_u32 v28, 144896, v6
    v_mul_u32_u24 v5, 0x90, v5
    v_lshl_add_u32 v5, v4, 4, v5
    v_add_u32 v29, 146944, v5
    s_cmp_eq_u32 s42, 0
    s_cselect_b32 s52, 768, 0
    v_add_u32 v30, s52, v165
    v_mov_b32 v11, 108032
    v_add_u32 v4, -16768, v162
    s_cmp_lg_u32 s42, 3
    s_cbranch_scc1 L_w0
    s_waitcnt vmcnt(9)
    s_mov_b64 exec, 0x1fff
    ds_write_b32 v4, v27
    v_mov_b32 v4, 0
    s_mov_b64 exec, 1
    global_atomic_add v27, v4, v163, s[38:39] sc0 sc1
    s_mov_b64 exec, -1
    s_waitcnt vmcnt(1)
    s_branch L_w1
L_w0:
    s_cmp_lg_u32 s42, 2
    s_cbranch_scc1 L_w2
    s_waitcnt vmcnt(10)
    s_branch L_w1
L_w2:
    s_waitcnt vmcnt(0)
L_w1:
    s_barrier
    ds_read_b64_tr_b16 v[96:97], v2 offset:0
    ds_read_b64_tr_b16 v[98:99], v3 offset:0
    ds_read_b64_tr_b16 v[100:101], v2 offset:32
    ds_read_b64_tr_b16 v[102:103], v3 offset:32
    ds_read_b64_tr_b16 v[104:105], v2 offset:64
    ds_read_b64_tr_b16 v[106:107], v3 offset:64
    ds_read_b64_tr_b16 v[108:109], v2 offset:96
    ds_read_b64_tr_b16 v[110:111], v3 offset:96
    ds_read_b64_tr_b16 v[112:113], v2 offset:128
    ds_read_b64_tr_b16 v[114:115], v3 offset:128
    ds_read_b64_tr_b16 v[116:117], v2 offset:160
    ds_read_b64_tr_b16 v[118:119], v3 offset:160
    v_add_u32_sdwa v80, v11, v32 dst_sel:DWORD dst_unused:UNUSED_PAD src0_sel:DWORD src1_sel:WORD_0
    v_add_u32_sdwa v81, v11, v32 dst_sel:DWORD dst_unused:UNUSED_PAD src0_sel:DWORD src1_sel:WORD_1
    v_add_u32_sdwa v82, v11, v33 dst_sel:DWORD dst_unused:UNUSED_PAD src0_sel:DWORD src1_sel:WORD_0
    v_add_u32_sdwa v83, v11, v33 dst_sel:DWORD dst_unused:UNUSED_PAD src0_sel:DWORD src1_sel:WORD_1
    v_add_u32_sdwa v84, v11, v34 dst_sel:DWORD dst_unused:UNUSED_PAD src0_sel:DWORD src1_sel:WORD_0
    v_add_u32_sdwa v85, v11, v34 dst_sel:DWORD dst_unused:UNUSED_PAD src0_sel:DWORD src1_sel:WORD_1
    v_add_u32_sdwa v86, v11, v35 dst_sel:DWORD dst_unused:UNUSED_PAD src0_sel:DWORD src1_sel:WORD_0
    v_add_u32_sdwa v87, v11, v35 dst_sel:DWORD dst_unused:UNUSED_PAD src0_sel:DWORD src1_sel:WORD_1
    ds_read_b64_tr_b16 v[120:121], v2 offset:192
    ds_read_b64_tr_b16 v[122:123], v3 offset:192
    s_waitcnt lgkmcnt(12)
    v_mfma_f32_16x16x32_bf16 v[12:15], v[56:59], v[96:99], 0
    ds_read_b64_tr_b16 v[124:125], v2 offset:224
    ds_read_b64_tr_b16 v[126:127], v3 offset:224
    s_waitcnt lgkmcnt(12)
    v_mfma_f32_16x16x32_bf16 v[12:15], v[60:63], v[100:103], v[12:15]
    ds_read_b64_tr_b16 v[128:129], v2 offset:256
    ds_read_b64_tr_b16 v[130:131], v3 offset:256
    s_waitcnt lgkmcnt(12)
    v_mfma_f32_16x16x32_bf16 v[12:15], v[64:67], v[104:107], v[12:15]
    ds_read_b64_tr_b16 v[132:133], v2 offset:288
    ds_read_b64_tr_b16 v[134:135], v3 offset:288
    s_waitcnt lgkmcnt(12)
    v_mfma_f32_16x16x32_bf16 v[12:15], v[68:71], v[108:111], v[12:15]
    ds_read_b64_tr_b16 v[136:137], v2 offset:320
    ds_read_b64_tr_b16 v[138:139], v3 offset:320
    s_waitcnt lgkmcnt(12)
    v_mfma_f32_16x16x32_bf16 v[16:19], v[56:59], v[112:115], 0
    ds_read_b64_tr_b16 v[140:141], v2 offset:352
    ds_read_b64_tr_b16 v[142:143], v3 offset:352
    s_waitcnt lgkmcnt(12)
    v_mfma_f32_16x16x32_bf16 v[16:19], v[60:63], v[116:119], v[16:19]
    s_waitcnt lgkmcnt(10)
    v_mfma_f32_16x16x32_bf16 v[16:19], v[64:67], v[120:123], v[16:19]
    v_add_u32_sdwa v88, v11, v36 dst_sel:DWORD dst_unused:UNUSED_PAD src0_sel:DWORD src1_sel:WORD_0
    v_add_u32_sdwa v89, v11, v36 dst_sel:DWORD dst_unused:UNUSED_PAD src0_sel:DWORD src1_sel:WORD_1
    s_waitcnt lgkmcnt(8)
    v_mfma_f32_16x16x32_bf16 v[16:19], v[68:71], v[124:127], v[16:19]
    v_add_u32_sdwa v90, v11, v37 dst_sel:DWORD dst_unused:UNUSED_PAD src0_sel:DWORD src1_sel:WORD_0
    v_add_u32_sdwa v91, v11, v37 dst_sel:DWORD dst_unused:UNUSED_PAD src0_sel:DWORD src1_sel:WORD_1
    s_waitcnt lgkmcnt(6)
    v_mfma_f32_16x16x32_bf16 v[20:23], v[56:59], v[128:131], 0
    v_cvt_pk_bf16_f32 v24, v12, v12
    ds_write_b16 v8, v24
    s_waitcnt lgkmcnt(4)
    v_mfma_f32_16x16x32_bf16 v[20:23], v[60:63], v[132:135], v[20:23]
    v_add_u32_sdwa v92, v11, v38 dst_sel:DWORD dst_unused:UNUSED_PAD src0_sel:DWORD src1_sel:WORD_0
    v_add_u32_sdwa v93, v11, v38 dst_sel:DWORD dst_unused:UNUSED_PAD src0_sel:DWORD src1_sel:WORD_1
    s_waitcnt lgkmcnt(2)
    v_mfma_f32_16x16x32_bf16 v[20:23], v[64:67], v[136:139], v[20:23]
    v_add_u32_sdwa v94, v11, v39 dst_sel:DWORD dst_unused:UNUSED_PAD src0_sel:DWORD src1_sel:WORD_0
    v_add_u32_sdwa v95, v11, v39 dst_sel:DWORD dst_unused:UNUSED_PAD src0_sel:DWORD src1_sel:WORD_1
    s_waitcnt lgkmcnt(0)
    v_mfma_f32_16x16x32_bf16 v[20:23], v[68:71], v[140:143], v[20:23]
    v_lshl_or_b32 v72, v41, 16, v40
    v_lshl_or_b32 v73, v43, 16, v42
    v_cvt_pk_bf16_f32 v25, v16, v16
    ds_write_b16 v9, v25
    v_lshl_or_b32 v74, v45, 16, v44
    v_lshl_or_b32 v75, v47, 16, v46
    v_lshl_or_b32 v76, v49, 16, v48
    v_lshl_or_b32 v77, v51, 16, v50
    v_lshl_or_b32 v78, v53, 16, v52
    v_lshl_or_b32 v79, v55, 16, v54
    v_cvt_pk_bf16_f32 v26, v20, v20
    ds_write_b16 v10, v26
    s_waitcnt lgkmcnt(0)
    s_barrier
    s_cmp_eq_u32 s42, 0
    s_cbranch_scc1 L_pT
    s_cmp_eq_u32 s42, 1
    s_cbranch_scc1 L_pX
    s_cmp_eq_u32 s42, 3
    s_cselect_b32 s52, 128, 64
    v_mov_b32 v2, s52
    v_mov_b32 v3, 26
    s_mov_b64 exec, 1
    s_cbranch_scc1 L_n2
    v_mov_b32 v4, 4
    s_waitcnt vmcnt(0)
    global_atomic_add v27, v4, v163, s[38:39] sc0 sc1
L_n2:
    s_waitcnt vmcnt(0)
    v_readfirstlane_b32 s51, v27
    s_cmp_lt_u32 s51, 25
    s_cbranch_scc1 L_pdx
    global_store_dword v2, v3, s[38:39] sc1
    s_branch L_pdx
L_pX:
    v_mov_b32 v112, 0
    v_mov_b32 v113, 0
    v_mov_b32 v114, 0
    v_mov_b32 v115, 0
    v_mov_b32 v116, 0
    v_mov_b32 v117, 0
    v_mov_b32 v118, 0
    v_mov_b32 v119, 0
    v_mov_b32 v120, 0
    v_mov_b32 v121, 0
    v_mov_b32 v122, 0
    v_mov_b32 v123, 0
    v_mov_b32 v124, 0
    v_mov_b32 v125, 0
    v_mov_b32 v126, 0
    v_mov_b32 v127, 0
    ds_read_u16_d16_hi v112, v80
    ds_read_u16_d16_hi v113, v81
    ds_read_u16_d16_hi v114, v82
    ds_read_u16_d16_hi v115, v83
    ds_read_u16_d16_hi v116, v84
    ds_read_u16_d16_hi v117, v85
    ds_read_u16_d16_hi v118, v86
    ds_read_u16_d16_hi v119, v87
    ds_read_u16_d16_hi v120, v88
    ds_read_u16_d16_hi v121, v89
    ds_read_u16_d16_hi v122, v90
    ds_read_u16_d16_hi v123, v91
    ds_read_u16_d16_hi v124, v92
    ds_read_u16_d16_hi v125, v93
    ds_read_u16_d16_hi v126, v94
    ds_read_u16_d16_hi v127, v95
    s_branch L_pst
L_pT:
    ds_read_b128 v[12:15], v28
    ds_read_b128 v[16:19], v28 offset:32
    s_waitcnt lgkmcnt(1)
    v_mfma_f32_32x32x16_bf16 v[96:111], v[72:75], v[12:15], 0
    s_waitcnt lgkmcnt(0)
    v_mfma_f32_32x32x16_bf16 v[96:111], v[76:79], v[16:19], v[96:111]
    s_nop 11
    ds_write_b128 v29, v[96:99] offset:0
    ds_write_b128 v29, v[100:103] offset:32
    ds_write_b128 v29, v[104:107] offset:64
    ds_write_b128 v29, v[108:111] offset:96
    ds_read_b32 v112, v80
    ds_read_b32 v113, v81
    ds_read_b32 v114, v82
    ds_read_b32 v115, v83
    ds_read_b32 v116, v84
    ds_read_b32 v117, v85
    ds_read_b32 v118, v86
    ds_read_b32 v119, v87
    ds_read_b32 v120, v88
    ds_read_b32 v121, v89
    ds_read_b32 v122, v90
    ds_read_b32 v123, v91
    ds_read_b32 v124, v92
    ds_read_b32 v125, v93
    ds_read_b32 v126, v94
    ds_read_b32 v127, v95
L_pst:
    s_mov_b32 exec_hi, 0xffff
    s_waitcnt lgkmcnt(12)
    v_add_f32 v112, v112, v113
    v_add_f32 v114, v114, v115
    v_cvt_pk_bf16_f32 v4, v112, v114
    v_min_u32 v4, -2, v4
    s_waitcnt lgkmcnt(8)
    v_add_f32 v116, v116, v117
    v_add_f32 v118, v118, v119
    v_cvt_pk_bf16_f32 v5, v116, v118
    v_min_u32 v5, -2, v5
    s_waitcnt lgkmcnt(4)
    v_add_f32 v120, v120, v121
    v_add_f32 v122, v122, v123
    v_cvt_pk_bf16_f32 v6, v120, v122
    v_min_u32 v6, -2, v6
    s_waitcnt lgkmcnt(0)
    v_add_f32 v124, v124, v125
    v_add_f32 v126, v126, v127
    v_cvt_pk_bf16_f32 v7, v124, v126
    v_min_u32 v7, -2, v7
    buffer_store_dwordx4 v[4:7], v30, s[32:35], s54 offen sc1
    s_cmp_lg_u32 s42, 0
    s_cbranch_scc1 L_pdx
    v_lshlrev_b32 v8, 2, v0
    s_mov_b32 exec_hi, 0
    buffer_store_dword v163, v8, s[32:35], s54 offen offset:1536 sc1
L_pdx:
    s_mov_b64 exec, -1
L_pdone:
    s_branch L_setup
L_xwave:
    s_mov_b64 exec, -1
    s_mov_b32 s22, 156
    s_mov_b32 s23, 0x20000
    s_mov_b32 s34, 305408
    s_mov_b32 s35, 0x20000
    s_mov_b32 s50, 0x40000
    v_lshlrev_b32 v162, 2, v0
    v_add_u32 v162, 163328, v162
    v_mov_b32 v163, 1
    s_mov_b64 s[12:13], s[60:61]
    s_mov_b64 s[20:21], s[58:59]
    s_load_dword s40, s[66:67], 0
    s_mov_b64 s[8:9], s[54:55]
    s_mov_b32 s10, 6400000
    s_mov_b32 s11, 0x20000
    v_lshrrev_b32 v1, 4, v0
    v_and_b32 v2, 12, v0
    s_mul_i32 s3, s47, 104
    s_add_u32 s3, s3, 154112
    v_add_u32 v2, s3, v2
    s_movk_i32 s51, 416
    v_mad_u32_u24 v3, v1, s51, v2
    v_add_u32 v4, 0x680, v3
    v_and_b32 v1, 3, v0
    v_lshlrev_b32 v5, 4, v1
    v_bfe_u32 v1, v0, 3, 1
    v_lshl_add_u32 v6, v1, 30, v5
    s_mul_i32 s56, s47, 7168
    s_lshr_b32 s57, s2, 4
    s_lshl2_add_u32 s57, s57, s47
    s_mul_i32 s57, s57, 5888
    s_add_u32 s57, s57, 638976
    s_lshr_b32 s45, s2, 6
    s_sub_u32 s45, s43, s45
    s_sub_u32 s45, s45, 1
    s_and_b32 s51, s2, 0x37
    s_sub_u32 s51, s51, 1
    s_cmp_lt_u32 s51, 7
    s_cselect_b32 s45, s45, 99
    s_waitcnt vmcnt(1)
    s_barrier
    ds_read2_b32 v[170:171], v3 offset0:0 offset1:4
    ds_read2_b32 v[172:173], v3 offset0:8 offset1:12
    ds_read2_b32 v[174:175], v3 offset0:16 offset1:20
    ds_read_b32 v176, v3 offset:96
    ds_read2_b32 v[178:179], v4 offset0:0 offset1:4
    ds_read2_b32 v[180:181], v4 offset0:8 offset1:12
    ds_read2_b32 v[182:183], v4 offset0:16 offset1:20
    ds_read_b32 v184, v4 offset:96
    s_waitcnt lgkmcnt(0)
    s_add_u32 m0, s56, 0
    v_lshl_add_u32 v170, v170, 6, v5
    buffer_load_dwordx4 v170, s[8:11], 0 offen lds
    s_add_u32 m0, s56, 28672
    v_lshl_add_u32 v178, v178, 6, v5
    buffer_load_dwordx4 v178, s[8:11], 0 offen lds
    s_add_u32 m0, s56, 1024
    v_lshl_add_u32 v171, v171, 6, v5
    buffer_load_dwordx4 v171, s[8:11], 0 offen lds
    s_add_u32 m0, s56, 29696
    v_lshl_add_u32 v179, v179, 6, v5
    buffer_load_dwordx4 v179, s[8:11], 0 offen lds
    s_cmp_ge_u32 s45, 26
    s_cbranch_scc1 L_nobar
    s_barrier
    s_barrier
L_nobar:
    s_waitcnt vmcnt(3)
    s_add_u32 m0, s56, 2048
    v_lshl_add_u32 v172, v172, 6, v5
    buffer_load_dwordx4 v172, s[8:11], 0 offen lds
    s_waitcnt vmcnt(3)
    s_add_u32 m0, s56, 30720
    v_lshl_add_u32 v180, v180, 6, v5
    buffer_load_dwordx4 v180, s[8:11], 0 offen lds
    s_waitcnt vmcnt(3)
    s_add_u32 m0, s56, 3072
    v_lshl_add_u32 v173, v173, 6, v5
    buffer_load_dwordx4 v173, s[8:11], 0 offen lds
    s_waitcnt vmcnt(3)
    s_add_u32 m0, s56, 31744
    v_lshl_add_u32 v181, v181, 6, v5
    buffer_load_dwordx4 v181, s[8:11], 0 offen lds
    s_waitcnt vmcnt(3)
    s_add_u32 m0, s56, 4096
    v_lshl_add_u32 v174, v174, 6, v5
    buffer_load_dwordx4 v174, s[8:11], 0 offen lds
    s_waitcnt vmcnt(3)
    s_add_u32 m0, s56, 32768
    v_lshl_add_u32 v182, v182, 6, v5
    buffer_load_dwordx4 v182, s[8:11], 0 offen lds
    s_waitcnt vmcnt(3)
    s_add_u32 m0, s56, 5120
    v_lshl_add_u32 v175, v175, 6, v5
    buffer_load_dwordx4 v175, s[8:11], 0 offen lds
    s_waitcnt vmcnt(3)
    s_add_u32 m0, s56, 33792
    v_lshl_add_u32 v183, v183, 6, v5
    buffer_load_dwordx4 v183, s[8:11], 0 offen lds
    s_waitcnt vmcnt(3)
    s_add_u32 m0, s56, 6144
    v_lshl_add_u32 v176, v176, 6, v6
    buffer_load_dwordx4 v176, s[8:11], 0 offen lds
    s_waitcnt vmcnt(3)
    s_add_u32 m0, s56, 34816
    v_lshl_add_u32 v184, v184, 6, v6
    buffer_load_dwordx4 v184, s[8:11], 0 offen lds
    s_waitcnt vmcnt(2)
    s_mov_b64 exec, 1
    ds_add_u32 v162, v163 offset:16
    s_mov_b64 exec, -1
    s_waitcnt vmcnt(0)
    s_mov_b64 exec, 1
    ds_add_u32 v162, v163 offset:8
    s_mov_b64 exec, -1
L_setup:
    s_setprio 3
    s_and_b32 s55, s42, 3
    s_lshl_b32 s54, s55, 2
    s_lshl_b32 s52, s55, 8
    s_mov_b32 s59, 4
    s_add_u32 s54, s54, 3
    s_cmp_lt_u32 s42, 4
    s_cbranch_scc1 L_rowp
    s_add_u32 s52, s52, 28672
    s_add_u32 s54, s54, 64
L_rowp:
    s_lshl4_add_u32 s54, s44, s54
L_setup2:
    s_mov_b32 s64, s59
    v_and_b32 v1, 31, v0
    v_lshrrev_b32 v2, 5, v0
    v_lshl_add_u32 v3, v1, 1, s52
    v_lshl_add_u32 v98, v2, 6, v3
    v_mul_u32_u24 v4, 0xc0, v2
    v_sub_u32 v99, v3, v4
    v_lshlrev_b32 v4, 6, v2
    v_sub_u32 v100, v3, v4
    v_mul_u32_u24 v4, 0x210, v2
    v_lshl_add_u32 v4, v1, 4, v4
    v_add_u32 v101, 57344, v4
    v_mov_b32 v48, 0
    v_mov_b32 v49, 0
    v_mov_b32 v50, 0
    v_mov_b32 v51, 0
    v_mov_b32 v52, 0
    v_mov_b32 v53, 0
    v_mov_b32 v54, 0
    v_mov_b32 v55, 0
    v_mov_b32 v56, 0
    v_mov_b32 v57, 0
    v_mov_b32 v58, 0
    v_mov_b32 v59, 0
    v_mov_b32 v60, 0
    v_mov_b32 v61, 0
    v_mov_b32 v62, 0
    v_mov_b32 v63, 0
    v_mov_b32 v64, 0
    v_mov_b32 v65, 0
    v_mov_b32 v66, 0
    v_mov_b32 v67, 0
    v_mov_b32 v68, 0
    v_mov_b32 v69, 0
    v_mov_b32 v70, 0
    v_mov_b32 v71, 0
    v_mov_b32 v72, 0
    v_mov_b32 v73, 0
    s_lshl_b32 s40, s40, 16
    v_lshrrev_b32 v1, 3, v0
    v_min_u32 v3, 1, v1
    v_lshlrev_b32 v2, 9, v0
    v_lshl_add_u32 v110, v3, 30, v2
    s_lshl_b32 s53, s43, 7
    s_add_u32 s53, s53, s54
    s_lshl_b32 s63, s53, 1
    s_lshl_b32 s52, s43, 10
    s_add_u32 s61, s54, s52
    s_sub_u32 s61, s61, 3
    s_lshl_b32 s61, s61, 2
    s_add_u32 s62, s61, 0x20000
    v_mov_b32 v97, 0
    v_mov_b32 v107, 0
    s_and_b32 s66, s42, 3
    s_cmp_ge_u32 s42, 4
    s_cbranch_scc1 L_xz
    v_and_b32 v2, 7, v0
    v_mul_u32_u24 v3, 1664, v1
    v_lshl_add_u32 v3, v2, 4, v3
    v_mul_u32_u24 v4, 0x210, v2
    s_mul_i32 s52, s66, 12672
    s_add_u32 s52, s52, 57344
    v_add_u32 v4, s52, v4
    v_lshl_add_u32 v5, v1, 4, v4
    v_cmp_eq_u32 vcc, 1, v1
    v_add_u32 v6, 48, v5
    v_subrev_u32 v7, 48, v5
    v_cndmask_b32 v6, v5, v6, vcc
    v_cmp_eq_u32 vcc, 4, v1
    v_mul_u32_u24 v8, 1664, v0
    s_nop 0
    v_cndmask_b32 v6, v6, v7, vcc
    s_mul_i32 s52, s66, 384
    s_add_u32 s52, s52, 262144
    s_and_b32 s53, s44, 1
    s_mul_i32 s54, s53, 26624
    s_xor_b32 s55, s54, 0
    s_add_u32 s55, s55, s52
    s_xor_b32 s56, s54, 0
    s_add_u32 s56, s56, s52
    s_add_u32 s56, s56, 13312
    s_xor_b32 s57, s54, 26624
    s_add_u32 s57, s57, s52
    s_xor_b32 s58, s54, 26624
    s_add_u32 s58, s58, s52
    s_add_u32 s58, s58, 13312
    s_lshl_b32 s54, s53, 8
    s_cmp_eq_u32 s53, 0
    s_cselect_b64 vcc, -1, 0
    v_add_u32 v12, s54, v5
    s_xor_b32 s54, s54, 0x100
    v_add_u32 v6, 0x180, v6
    v_add_u32 v15, 0x80, v5
    v_add_u32 v14, s54, v5
    v_cndmask_b32 v13, v6, v15, vcc
    v_cndmask_b32 v15, v15, v6, vcc
    v_mov_b32 v10, 0
L_spin_2:
    s_sleep 2
    ds_read_b32 v164, v162 offset:16
    s_waitcnt lgkmcnt(0)
    v_readfirstlane_b32 s51, v164
    s_sub_u32 s50, s50, 1
    s_cbranch_scc1 L_end
    s_cmp_ge_u32 s51, 4
    s_cbranch_scc0 L_spin_2
L_ok_1:
    s_mov_b32 s65, 262144
    s_load_dword s16, s[38:39], 128
    s_waitcnt lgkmcnt(0)
    s_cmp_ge_u32 s16, 26
    s_cbranch_scc1 L_wload
    s_cmp_lg_u32 s42, 0
    s_cbranch_scc1 L_pw
L_probe:
    global_load_dword v11, v10, s[38:39] offset:128 sc1
    buffer_load_dword v9, v8, s[32:35], s65 offen offset:1536 sc1
    s_waitcnt vmcnt(0)
    v_cmp_gt_u32 vcc, 26, v11
    v_cmp_eq_u32 s[16:17], -1, v9
    s_nop 1
    s_or_b64 vcc, vcc, s[16:17]
    s_cmp_eq_u64 vcc, 0
    s_cbranch_scc1 L_wload
L_retry:
    s_sleep 2
    s_sub_u32 s50, s50, 1
    s_cbranch_scc0 L_probe
    s_endpgm
L_pw:
L_spin_4:
    s_sleep 2
    ds_read_b32 v164, v162 offset:12
    s_waitcnt lgkmcnt(0)
    v_readfirstlane_b32 s51, v164
    s_sub_u32 s50, s50, 1
    s_cbranch_scc1 L_end
    s_cmp_ge_u32 s51, 1
    s_cbranch_scc0 L_spin_4
L_ok_3:
    s_branch L_wl2
L_wload:
    s_mov_b64 exec, 1
    ds_add_u32 v162, v163 offset:12
    s_mov_b64 exec, -1
L_wl2:
    buffer_load_dwordx4 v[112:115], v3, s[32:35], s55 offen offset:0 sc1
    buffer_load_dwordx4 v[116:119], v3, s[32:35], s55 offen offset:128 sc1
    buffer_load_dwordx4 v[120:123], v3, s[32:35], s55 offen offset:256 sc1
    buffer_load_dwordx4 v[124:127], v3, s[32:35], s56 offen offset:0 sc1
    buffer_load_dwordx4 v[128:131], v3, s[32:35], s56 offen offset:128 sc1
    buffer_load_dwordx4 v[132:135], v3, s[32:35], s56 offen offset:256 sc1
    buffer_load_dwordx4 v[136:139], v3, s[32:35], s57 offen offset:0 sc1
    buffer_load_dwordx4 v[140:143], v3, s[32:35], s57 offen offset:128 sc1
    buffer_load_dwordx4 v[144:147], v3, s[32:35], s57 offen offset:256 sc1
    buffer_load_dwordx4 v[148:151], v3, s[32:35], s58 offen offset:0 sc1
    buffer_load_dwordx4 v[152:155], v3, s[32:35], s58 offen offset:128 sc1
    buffer_load_dwordx4 v[156:159], v3, s[32:35], s58 offen offset:256 sc1
    s_cmp_lg_u32 s66, 99
    s_cbranch_scc0 L_zd
L_spin_6:
    s_sleep 1
    ds_read_b32 v164, v162 offset:8
    s_waitcnt lgkmcnt(0)
    v_readfirstlane_b32 s51, v164
    s_sub_u32 s50, s50, 1
    s_cbranch_scc1 L_end
    s_cmp_ge_u32 s51, 4
    s_cbranch_scc0 L_spin_6
L_ok_5:
    ds_read_u16_d16_hi v48, v98 offset:0
    ds_read_u16_d16_hi v49, v98 offset:64
    ds_read_u16_d16_hi v50, v98 offset:128
    ds_read_u16_d16_hi v51, v99 offset:192
    ds_read_u16_d16_hi v52, v98 offset:1024
    ds_read_u16_d16_hi v53, v98 offset:1088
    ds_read_u16_d16_hi v54, v98 offset:1152
    ds_read_u16_d16_hi v55, v99 offset:1216
    ds_read_u16_d16_hi v56, v98 offset:2048
    ds_read_u16_d16_hi v57, v98 offset:2112
    ds_read_u16_d16_hi v58, v98 offset:2176
    ds_read_u16_d16_hi v59, v99 offset:2240
    ds_read_u16_d16_hi v60, v98 offset:3072
    ds_read_u16_d16_hi v61, v98 offset:3136
    ds_read_u16_d16_hi v62, v98 offset:3200
    ds_read_u16_d16_hi v63, v99 offset:3264
    ds_read_u16_d16_hi v64, v98 offset:4096
    ds_read_u16_d16_hi v65, v98 offset:4160
    ds_read_u16_d16_hi v66, v98 offset:4224
    ds_read_u16_d16_hi v67, v99 offset:4288
    ds_read_u16_d16_hi v68, v98 offset:5120
    ds_read_u16_d16_hi v69, v98 offset:5184
    ds_read_u16_d16_hi v70, v98 offset:5248
    ds_read_u16_d16_hi v71, v99 offset:5312
    ds_read_u16_d16_hi v72, v98 offset:6144
    ds_read_u16_d16_hi v73, v100 offset:6208
    s_waitcnt lgkmcnt(15)
    v_mul_f32 v82, v48, v48
    v_mul_f32 v83, v48, v49
    v_mul_f32 v84, v48, v50
    v_mul_f32 v85, v48, v52
    v_cvt_pk_bf16_f32 v74, v82, v83
    v_mul_f32 v86, v50, v50
    v_mul_f32 v87, v48, v53
    v_cvt_pk_bf16_f32 v75, v84, v85
    v_mul_f32 v88, v50, v51
    v_mul_f32 v89, v48, v54
    v_cvt_pk_bf16_f32 v76, v86, v87
    v_cvt_pk_bf16_f32 v77, v88, v89
    v_add_u32 v98, 0x1c00, v98
    v_add_u32 v99, 0x1c00, v99
    v_add_u32 v100, 0x1c00, v100
    s_mov_b32 s66, 99
L_zd:
    s_waitcnt vmcnt(11)
    ds_write_b128 v12, v[112:115] offset:0
    v_max_u32 v9, v112, v113
    v_max3_u32 v9, v114, v115, v9
    s_waitcnt vmcnt(10)
    ds_write_b128 v12, v[116:119] offset:4224
    v_max3_u32 v9, v116, v117, v9
    v_max3_u32 v9, v118, v119, v9
    s_waitcnt vmcnt(9)
    ds_write_b128 v12, v[120:123] offset:8448
    v_max3_u32 v9, v120, v121, v9
    v_max3_u32 v9, v122, v123, v9
    s_waitcnt vmcnt(8)
    ds_write_b128 v13, v[124:127] offset:0
    v_max3_u32 v9, v124, v125, v9
    v_max3_u32 v9, v126, v127, v9
    s_waitcnt vmcnt(7)
    ds_write_b128 v13, v[128:131] offset:4224
    v_max3_u32 v9, v128, v129, v9
    v_max3_u32 v9, v130, v131, v9
    s_waitcnt vmcnt(6)
    ds_write_b128 v13, v[132:135] offset:8448
    v_max3_u32 v9, v132, v133, v9
    v_max3_u32 v9, v134, v135, v9
    s_waitcnt vmcnt(5)
    ds_write_b128 v14, v[136:139] offset:0
    v_max3_u32 v9, v136, v137, v9
    v_max3_u32 v9, v138, v139, v9
    s_waitcnt vmcnt(4)
    ds_write_b128 v14, v[140:143] offset:4224
    v_max3_u32 v9, v140, v141, v9
    v_max3_u32 v9, v142, v143, v9
    s_waitcnt vmcnt(3)
    ds_write_b128 v14, v[144:147] offset:8448
    v_max3_u32 v9, v144, v145, v9
    v_max3_u32 v9, v146, v147, v9
    s_waitcnt vmcnt(2)
    ds_write_b128 v15, v[148:151] offset:0
    v_max3_u32 v9, v148, v149, v9
    v_max3_u32 v9, v150, v151, v9
    s_waitcnt vmcnt(1)
    ds_write_b128 v15, v[152:155] offset:4224
    v_max3_u32 v9, v152, v153, v9
    v_max3_u32 v9, v154, v155, v9
    s_waitcnt vmcnt(0)
    ds_write_b128 v15, v[156:159] offset:8448
    v_max3_u32 v9, v156, v157, v9
    v_max3_u32 v9, v158, v159, v9
    v_cmp_eq_u32 vcc, -1, v9
    s_nop 1
    s_cmp_eq_u64 vcc, 0
    s_cbranch_scc0 L_retry
    s_branch L_xz2
L_xz:
L_spin_8:
    s_sleep 1
    ds_read_b32 v164, v162 offset:8
    s_waitcnt lgkmcnt(0)
    v_readfirstlane_b32 s51, v164
    s_sub_u32 s50, s50, 1
    s_cbranch_scc1 L_end
    s_cmp_ge_u32 s51, 4
    s_cbranch_scc0 L_spin_8
L_ok_7:
    ds_read_u16_d16_hi v48, v98 offset:0
    ds_read_u16_d16_hi v49, v98 offset:64
    ds_read_u16_d16_hi v50, v98 offset:128
    ds_read_u16_d16_hi v51, v99 offset:192
    ds_read_u16_d16_hi v52, v98 offset:1024
    ds_read_u16_d16_hi v53, v98 offset:1088
    ds_read_u16_d16_hi v54, v98 offset:1152
    ds_read_u16_d16_hi v55, v99 offset:1216
    ds_read_u16_d16_hi v56, v98 offset:2048
    ds_read_u16_d16_hi v57, v98 offset:2112
    ds_read_u16_d16_hi v58, v98 offset:2176
    ds_read_u16_d16_hi v59, v99 offset:2240
    ds_read_u16_d16_hi v60, v98 offset:3072
    ds_read_u16_d16_hi v61, v98 offset:3136
    ds_read_u16_d16_hi v62, v98 offset:3200
    ds_read_u16_d16_hi v63, v99 offset:3264
    ds_read_u16_d16_hi v64, v98 offset:4096
    ds_read_u16_d16_hi v65, v98 offset:4160
    ds_read_u16_d16_hi v66, v98 offset:4224
    ds_read_u16_d16_hi v67, v99 offset:4288
    ds_read_u16_d16_hi v68, v98 offset:5120
    ds_read_u16_d16_hi v69, v98 offset:5184
    ds_read_u16_d16_hi v70, v98 offset:5248
    ds_read_u16_d16_hi v71, v99 offset:5312
    ds_read_u16_d16_hi v72, v98 offset:6144
    ds_read_u16_d16_hi v73, v100 offset:6208
    s_waitcnt lgkmcnt(15)
    v_mul_f32 v82, v48, v48
    v_mul_f32 v83, v48, v49
    v_mul_f32 v84, v48, v50
    v_mul_f32 v85, v48, v52
    v_cvt_pk_bf16_f32 v74, v82, v83
    v_mul_f32 v86, v50, v50
    v_mul_f32 v87, v48, v53
    v_cvt_pk_bf16_f32 v75, v84, v85
    v_mul_f32 v88, v50, v51
    v_mul_f32 v89, v48, v54
    v_cvt_pk_bf16_f32 v76, v86, v87
    v_cvt_pk_bf16_f32 v77, v88, v89
    v_add_u32 v98, 0x1c00, v98
    v_add_u32 v99, 0x1c00, v99
    v_add_u32 v100, 0x1c00, v100
L_xz2:
    s_waitcnt lgkmcnt(0)
    s_barrier
L_go:
    s_setprio 0
    s_cmp_lt_u32 s42, 4
    s_cbranch_scc1 L_prio
    s_setprio 1
L_prio:
    ds_read_b128 v[32:35], v101 offset:0
    ds_read_b128 v[36:39], v101 offset:25344
    ds_read_b128 v[112:115], v101 offset:1056
    ds_read_b128 v[40:43], v101 offset:26400
    ds_read_b128 v[44:47], v101 offset:2112
    ds_read_b128 v[120:123], v101 offset:27456
    ds_read_u16_d16_hi v49, v98 offset:64
    ds_read_u16_d16_hi v51, v99 offset:192
    s_waitcnt lgkmcnt(7)
    v_mfma_f32_32x32x16_bf16 v[0:15], v[32:35], v[74:77], 0
    ds_read_b128 v[124:127], v101 offset:3168
    v_mul_f32 v82, v50, v52
    v_mul_f32 v83, v48, v55
    v_mul_f32 v84, v50, v53
    v_mul_f32 v85, v48, v56
    v_cvt_pk_bf16_f32 v78, v82, v83
    v_mul_f32 v86, v50, v54
    v_mul_f32 v87, v52, v52
    s_waitcnt lgkmcnt(7)
    v_mfma_f32_32x32x16_bf16 v[16:31], v[36:39], v[74:77], 0
    ds_read_b128 v[128:131], v101 offset:28512
    v_cvt_pk_bf16_f32 v79, v84, v85
    v_mul_f32 v88, v48, v57
    v_mul_f32 v89, v50, v55
    v_cvt_pk_bf16_f32 v80, v86, v87
    v_cvt_pk_bf16_f32 v81, v88, v89
    v_mul_f32 v82, v52, v53
    ds_read_u16_d16_hi v53, v98 offset:1088
    s_waitcnt lgkmcnt(8)
    v_mfma_f32_32x32x16_bf16 v[0:15], v[112:115], v[78:81], v[0:15]
    ds_read_b128 v[112:115], v101 offset:7392
    ds_read_b128 v[116:119], v101 offset:4224
    v_mul_f32 v83, v48, v58
    v_mul_f32 v84, v50, v56
    v_mul_f32 v85, v52, v54
    v_cvt_pk_bf16_f32 v74, v82, v83
    v_mul_f32 v86, v48, v59
    v_mul_f32 v87, v50, v57
    s_waitcnt lgkmcnt(9)
    v_mfma_f32_32x32x16_bf16 v[16:31], v[40:43], v[78:81], v[16:31]
    ds_read_b128 v[132:135], v101 offset:29568
    v_cvt_pk_bf16_f32 v75, v84, v85
    v_mul_f32 v88, v48, v60
    v_mul_f32 v89, v50, v58
    v_cvt_pk_bf16_f32 v76, v86, v87
    v_cvt_pk_bf16_f32 v77, v88, v89
    v_mul_f32 v82, v52, v56
    v_mul_f32 v83, v54, v54
    s_waitcnt lgkmcnt(9)
    v_mfma_f32_32x32x16_bf16 v[0:15], v[44:47], v[74:77], v[0:15]
    ds_read_b128 v[136:139], v101 offset:5280
    v_mul_f32 v84, v48, v61
    v_mul_f32 v85, v50, v59
    v_cvt_pk_bf16_f32 v78, v82, v83
    v_mul_f32 v86, v52, v57
    v_mul_f32 v87, v54, v55
    ds_read_u16_d16_hi v55, v99 offset:1216
    s_waitcnt lgkmcnt(10)
    v_mfma_f32_32x32x16_bf16 v[16:31], v[120:123], v[74:77], v[16:31]
    ds_read_b128 v[140:143], v101 offset:30624
    v_cvt_pk_bf16_f32 v79, v84, v85
    v_mul_f32 v88, v48, v62
    v_mul_f32 v89, v50, v60
    v_cvt_pk_bf16_f32 v80, v86, v87
    v_cvt_pk_bf16_f32 v81, v88, v89
    v_mul_f32 v82, v52, v58
    v_mul_f32 v83, v54, v56
    s_waitcnt lgkmcnt(8)
    v_mfma_f32_32x32x16_bf16 v[0:15], v[124:127], v[78:81], v[0:15]
    ds_read_b128 v[144:147], v101 offset:6336
    v_mul_f32 v84, v48, v63
    v_mul_f32 v85, v50, v61
    v_cvt_pk_bf16_f32 v74, v82, v83
    v_mul_f32 v86, v52, v59
    v_mul_f32 v87, v54, v57
    v_cvt_pk_bf16_f32 v75, v84, v85
    s_waitcnt lgkmcnt(8)
    v_mfma_f32_32x32x16_bf16 v[16:31], v[128:131], v[78:81], v[16:31]
    ds_read_b128 v[148:151], v101 offset:31680
    v_mul_f32 v88, v48, v64
    v_mul_f32 v89, v50, v62
    v_cvt_pk_bf16_f32 v76, v86, v87
    v_cvt_pk_bf16_f32 v77, v88, v89
    v_mul_f32 v82, v52, v60
    v_mul_f32 v83, v54, v58
    s_waitcnt lgkmcnt(6)
    v_mfma_f32_32x32x16_bf16 v[0:15], v[116:119], v[74:77], v[0:15]
    ds_read_b128 v[116:119], v101 offset:10560
    v_mul_f32 v84, v56, v56
    v_mul_f32 v85, v48, v65
    v_cvt_pk_bf16_f32 v78, v82, v83
    v_mul_f32 v86, v50, v63
    v_mul_f32 v87, v52, v61
    v_cvt_pk_bf16_f32 v79, v84, v85
    s_waitcnt lgkmcnt(6)
    v_mfma_f32_32x32x16_bf16 v[16:31], v[132:135], v[74:77], v[16:31]
    ds_read_b128 v[152:155], v101 offset:32736
    v_mul_f32 v88, v54, v59
    v_mul_f32 v89, v56, v57
    ds_read_u16_d16_hi v57, v98 offset:2112
    v_cvt_pk_bf16_f32 v80, v86, v87
    v_cvt_pk_bf16_f32 v81, v88, v89
    v_mul_f32 v82, v48, v66
    v_mul_f32 v83, v50, v64
    s_waitcnt lgkmcnt(7)
    v_mfma_f32_32x32x16_bf16 v[0:15], v[136:139], v[78:81], v[0:15]
    ds_read_b128 v[156:159], v101 offset:8448
    v_mul_f32 v84, v52, v62
    v_mul_f32 v85, v54, v60
    v_cvt_pk_bf16_f32 v74, v82, v83
    v_mul_f32 v86, v56, v58
    v_mul_f32 v87, v48, v67
    v_cvt_pk_bf16_f32 v75, v84, v85
    s_waitcnt lgkmcnt(6)
    v_mfma_f32_32x32x16_bf16 v[16:31], v[140:143], v[78:81], v[16:31]
    ds_read_b128 v[160:163], v101 offset:33792
    v_mul_f32 v88, v50, v65
    v_mul_f32 v89, v52, v63
    v_cvt_pk_bf16_f32 v76, v86, v87
    v_cvt_pk_bf16_f32 v77, v88, v89
    v_mul_f32 v82, v54, v61
    v_mul_f32 v83, v48, v68
    s_waitcnt lgkmcnt(6)
    v_mfma_f32_32x32x16_bf16 v[0:15], v[144:147], v[74:77], v[0:15]
    ds_read_b128 v[164:167], v101 offset:9504
    v_mul_f32 v84, v50, v66
    v_mul_f32 v85, v52, v64
    v_cvt_pk_bf16_f32 v78, v82, v83
    v_mul_f32 v86, v54, v62
    v_mul_f32 v87, v56, v60
    v_cvt_pk_bf16_f32 v79, v84, v85
    s_waitcnt lgkmcnt(6)
    v_mfma_f32_32x32x16_bf16 v[16:31], v[148:151], v[74:77], v[16:31]
    ds_read_b128 v[168:171], v101 offset:34848
    v_mul_f32 v88, v58, v58
    v_mul_f32 v89, v48, v69
    v_cvt_pk_bf16_f32 v80, v86, v87
    v_cvt_pk_bf16_f32 v81, v88, v89
    v_mul_f32 v82, v50, v67
    v_mul_f32 v83, v52, v65
    v_mfma_f32_32x32x16_bf16 v[0:15], v[112:115], v[78:81], v[0:15]
    ds_read_b128 v[112:115], v101 offset:38016
    v_mul_f32 v84, v54, v63
    v_mul_f32 v85, v56, v61
    v_cvt_pk_bf16_f32 v74, v82, v83
    v_mul_f32 v86, v58, v59
    ds_read_u16_d16_hi v59, v99 offset:2240
    v_mul_f32 v87, v48, v70
    s_waitcnt lgkmcnt(7)
    v_mfma_f32_32x32x16_bf16 v[16:31], v[152:155], v[78:81], v[16:31]
    ds_read_b128 v[172:175], v101 offset:35904
    v_cvt_pk_bf16_f32 v75, v84, v85
    v_mul_f32 v88, v50, v68
    v_mul_f32 v89, v52, v66
    v_cvt_pk_bf16_f32 v76, v86, v87
    v_cvt_pk_bf16_f32 v77, v88, v89
    v_mul_f32 v82, v54, v64
    v_mul_f32 v83, v56, v62
    s_waitcnt lgkmcnt(6)
    v_mfma_f32_32x32x16_bf16 v[0:15], v[156:159], v[74:77], v[0:15]
    ds_read_b128 v[176:179], v101 offset:11616
    v_mul_f32 v84, v58, v60
    v_mul_f32 v85, v48, v71
    v_cvt_pk_bf16_f32 v78, v82, v83
    v_mul_f32 v86, v50, v69
    v_mul_f32 v87, v52, v67
    v_cvt_pk_bf16_f32 v79, v84, v85
    s_waitcnt lgkmcnt(6)
    v_mfma_f32_32x32x16_bf16 v[16:31], v[160:163], v[74:77], v[16:31]
    ds_read_b128 v[180:183], v101 offset:36960
    v_mul_f32 v88, v54, v65
    v_mul_f32 v89, v56, v63
    v_cvt_pk_bf16_f32 v80, v86, v87
    v_cvt_pk_bf16_f32 v81, v88, v89
    v_mul_f32 v82, v58, v61
    v_mul_f32 v83, v48, v72
    s_waitcnt lgkmcnt(6)
    v_mfma_f32_32x32x16_bf16 v[0:15], v[164:167], v[78:81], v[0:15]
    ds_read_b128 v[184:187], v101 offset:12672
    v_mul_f32 v84, v50, v70
    v_mul_f32 v85, v52, v68
    v_cvt_pk_bf16_f32 v74, v82, v83
    v_mul_f32 v86, v54, v66
    v_mul_f32 v87, v56, v64
    v_cvt_pk_bf16_f32 v75, v84, v85
    s_waitcnt lgkmcnt(6)
    v_mfma_f32_32x32x16_bf16 v[16:31], v[168:171], v[78:81], v[16:31]
    v_mul_f32 v88, v58, v62
    v_mul_f32 v89, v60, v60
    v_cvt_pk_bf16_f32 v76, v86, v87
    v_cvt_pk_bf16_f32 v77, v88, v89
    v_cvt_pk_bf16_f32 v90, v48, v50
    v_cvt_pk_bf16_f32 v91, v52, v54
    v_mfma_f32_32x32x16_bf16 v[0:15], v[116:119], v[74:77], v[0:15]
    ds_read_b128 v[116:119], v101 offset:15840
    ds_read_b128 v[188:191], v101 offset:13728
    v_cvt_pk_bf16_f32 v92, v56, v58
    v_cvt_pk_bf16_f32 v93, v60, v62
    v_cvt_pk_bf16_f32 v94, v64, v66
    v_cvt_pk_bf16_f32 v95, v68, v70
    v_cvt_pk_bf16_f32 v96, v72, 1.0
    v_mul_f32 v82, v48, v73
    ds_read_u16_d16_hi v48, v98 offset:0
    v_mul_f32 v83, v50, v71
    v_mul_f32 v84, v52, v69
    v_mul_f32 v85, v54, v67
    s_waitcnt lgkmcnt(6)
    v_mfma_f32_32x32x16_bf16 v[16:31], v[172:175], v[74:77], v[16:31]
    ds_read_b128 v[192:195], v101 offset:39072
    v_cvt_pk_bf16_f32 v78, v82, v83
    v_mul_f32 v86, v56, v65
    v_mul_f32 v87, v58, v63
    v_cvt_pk_bf16_f32 v79, v84, v85
    v_mul_f32 v88, v60, v61
    ds_read_u16_d16_hi v61, v98 offset:3136
    v_mul_f32 v89, v50, v72
    v_cvt_pk_bf16_f32 v80, v86, v87
    v_cvt_pk_bf16_f32 v81, v88, v89
    v_mul_f32 v82, v52, v70
    v_mul_f32 v83, v54, v68
    s_waitcnt lgkmcnt(7)
    v_mfma_f32_32x32x16_bf16 v[0:15], v[176:179], v[78:81], v[0:15]
    ds_read_b128 v[196:199], v101 offset:14784
    v_mul_f32 v84, v56, v66
    v_mul_f32 v85, v58, v64
    v_cvt_pk_bf16_f32 v74, v82, v83
    v_mul_f32 v86, v60, v62
    v_mul_f32 v87, v50, v73
    ds_read_u16_d16_hi v50, v98 offset:128
    s_waitcnt lgkmcnt(8)
    v_mfma_f32_32x32x16_bf16 v[16:31], v[180:183], v[78:81], v[16:31]
    ds_read_b128 v[200:203], v101 offset:40128
    v_cvt_pk_bf16_f32 v75, v84, v85
    v_mul_f32 v88, v52, v71
    v_mul_f32 v89, v54, v69
    v_cvt_pk_bf16_f32 v76, v86, v87
    v_cvt_pk_bf16_f32 v77, v88, v89
    v_mul_f32 v82, v56, v67
    v_mul_f32 v83, v58, v65
    s_waitcnt lgkmcnt(8)
    v_mfma_f32_32x32x16_bf16 v[0:15], v[184:187], v[74:77], v[0:15]
    ds_read_b128 v[204:207], v101 offset:48576
    v_mul_f32 v84, v52, v72
    v_mul_f32 v85, v54, v70
    v_cvt_pk_bf16_f32 v78, v82, v83
    v_mul_f32 v86, v56, v68
    v_mul_f32 v87, v58, v66
    v_cvt_pk_bf16_f32 v79, v84, v85
    v_mfma_f32_32x32x16_bf16 v[16:31], v[112:115], v[74:77], v[16:31]
    ds_read_b128 v[112:115], v101 offset:19008
    v_mul_f32 v88, v60, v64
    v_mul_f32 v89, v62, v62
    v_cvt_pk_bf16_f32 v80, v86, v87
    v_cvt_pk_bf16_f32 v81, v88, v89
    v_mul_f32 v82, v52, v73
    ds_read_u16_d16_hi v52, v98 offset:1024
    s_waitcnt lgkmcnt(9)
    v_mfma_f32_32x32x16_bf16 v[0:15], v[188:191], v[78:81], v[0:15]
    ds_read_b128 v[208:211], v101 offset:41184
    v_mul_f32 v83, v54, v71
    v_mul_f32 v84, v56, v69
    v_mul_f32 v85, v58, v67
    v_cvt_pk_bf16_f32 v74, v82, v83
    v_mul_f32 v86, v60, v65
    v_mul_f32 v87, v62, v63
    ds_read_u16_d16_hi v63, v99 offset:3264
    s_waitcnt lgkmcnt(9)
    v_mfma_f32_32x32x16_bf16 v[16:31], v[192:195], v[78:81], v[16:31]
    ds_read_b128 v[212:215], v101 offset:16896
    v_cvt_pk_bf16_f32 v75, v84, v85
    v_mul_f32 v88, v54, v72
    v_mul_f32 v89, v56, v70
    v_cvt_pk_bf16_f32 v76, v86, v87
    v_cvt_pk_bf16_f32 v77, v88, v89
    v_mul_f32 v82, v58, v68
    v_mul_f32 v83, v60, v66
    s_waitcnt lgkmcnt(8)
    v_mfma_f32_32x32x16_bf16 v[0:15], v[196:199], v[74:77], v[0:15]
    ds_read_b128 v[216:219], v101 offset:42240
    v_mul_f32 v84, v62, v64
    v_mul_f32 v85, v54, v73
    ds_read_u16_d16_hi v54, v98 offset:1152
    v_cvt_pk_bf16_f32 v78, v82, v83
    s_waitcnt lgkmcnt(8)
    v_mfma_f32_32x32x16_bf16 v[16:31], v[200:203], v[74:77], v[16:31]
    ds_read_b128 v[220:223], v101 offset:17952
    v_mul_f32 v86, v56, v71
    v_mul_f32 v87, v58, v69
    v_cvt_pk_bf16_f32 v79, v84, v85
    v_mul_f32 v88, v60, v67
    s_waitcnt lgkmcnt(8)
    v_mfma_f32_32x32x16_bf16 v[16:31], v[204:207], v[90:93], v[16:31]
    ds_read_b128 v[224:227], v101 offset:43296
    v_mul_f32 v89, v62, v65
    v_cvt_pk_bf16_f32 v80, v86, v87
    v_cvt_pk_bf16_f32 v81, v88, v89
    v_mul_f32 v82, v56, v72
    v_mul_f32 v83, v58, v70
    v_mfma_f32_32x32x16_bf16 v[0:15], v[116:119], v[78:81], v[0:15]
    ds_read_b128 v[116:119], v101 offset:46464
    v_mul_f32 v84, v60, v68
    v_mul_f32 v85, v62, v66
    v_cvt_pk_bf16_f32 v74, v82, v83
    v_mul_f32 v86, v64, v64
    v_mul_f32 v87, v56, v73
    ds_read_u16_d16_hi v56, v98 offset:2048
    s_waitcnt lgkmcnt(8)
    v_mfma_f32_32x32x16_bf16 v[16:31], v[208:211], v[78:81], v[16:31]
    ds_read_b128 v[228:231], v101 offset:44352
    v_cvt_pk_bf16_f32 v75, v84, v85
    v_mul_f32 v88, v58, v71
    v_mul_f32 v89, v60, v69
    v_cvt_pk_bf16_f32 v76, v86, v87
    v_cvt_pk_bf16_f32 v77, v88, v89
    v_mul_f32 v82, v62, v67
    v_mul_f32 v83, v64, v65
    s_waitcnt lgkmcnt(7)
    v_mfma_f32_32x32x16_bf16 v[0:15], v[212:215], v[74:77], v[0:15]
    ds_read_b128 v[232:235], v101 offset:49632
    ds_read_u16_d16_hi v65, v98 offset:4160
    v_mul_f32 v84, v58, v72
    v_mul_f32 v85, v60, v70
    v_cvt_pk_bf16_f32 v78, v82, v83
    v_mul_f32 v86, v62, v68
    v_mul_f32 v87, v64, v66
    v_cvt_pk_bf16_f32 v79, v84, v85
    s_waitcnt lgkmcnt(8)
    v_mfma_f32_32x32x16_bf16 v[16:31], v[216:219], v[74:77], v[16:31]
    ds_read_b128 v[236:239], v101 offset:20064
    v_mul_f32 v88, v58, v73
    ds_read_u16_d16_hi v58, v98 offset:2176
    v_mul_f32 v89, v60, v71
    v_cvt_pk_bf16_f32 v80, v86, v87
    v_cvt_pk_bf16_f32 v81, v88, v89
    v_mul_f32 v82, v62, v69
    v_mul_f32 v83, v60, v72
    s_waitcnt lgkmcnt(8)
    v_mfma_f32_32x32x16_bf16 v[0:15], v[220:223], v[78:81], v[0:15]
    ds_read_b128 v[240:243], v101 offset:45408
    v_mul_f32 v84, v62, v70
    v_mul_f32 v85, v64, v68
    v_cvt_pk_bf16_f32 v74, v82, v83
    v_mul_f32 v86, v66, v66
    v_mul_f32 v87, v60, v73
    ds_read_u16_d16_hi v60, v98 offset:3072
    s_waitcnt lgkmcnt(9)
    v_mfma_f32_32x32x16_bf16 v[16:31], v[224:227], v[78:81], v[16:31]
    ds_read_b128 v[244:247], v101 offset:21120
    v_cvt_pk_bf16_f32 v75, v84, v85
    v_mul_f32 v88, v62, v71
    v_mul_f32 v89, v64, v69
    v_cvt_pk_bf16_f32 v76, v86, v87
    v_cvt_pk_bf16_f32 v77, v88, v89
    v_mul_f32 v82, v66, v67
    ds_read_u16_d16_hi v67, v99 offset:4288
    v_mfma_f32_32x32x16_bf16 v[0:15], v[112:115], v[74:77], v[0:15]
    ds_read_b128 v[112:115], v101 offset:1056
    v_mul_f32 v83, v62, v72
    v_mul_f32 v84, v64, v70
    v_mul_f32 v85, v66, v68
    v_cvt_pk_bf16_f32 v78, v82, v83
    s_waitcnt lgkmcnt(9)
    v_mfma_f32_32x32x16_bf16 v[16:31], v[228:231], v[74:77], v[16:31]
    ds_read_b128 v[248:251], v101 offset:22176
    v_mul_f32 v86, v62, v73
    ds_read_u16_d16_hi v62, v98 offset:3200
    v_mul_f32 v87, v64, v71
    v_cvt_pk_bf16_f32 v79, v84, v85
    v_mul_f32 v88, v66, v69
    s_waitcnt lgkmcnt(10)
    v_mfma_f32_32x32x16_bf16 v[16:31], v[232:235], v[94:97], v[16:31]
    ds_read_b128 v[252:255], v101 offset:47520
    v_mul_f32 v89, v64, v72
    v_cvt_pk_bf16_f32 v80, v86, v87
    v_cvt_pk_bf16_f32 v81, v88, v89
    v_mul_f32 v82, v66, v70
    v_mul_f32 v83, v68, v68
    s_waitcnt lgkmcnt(9)
    v_mfma_f32_32x32x16_bf16 v[0:15], v[236:239], v[78:81], v[0:15]
    v_mul_f32 v84, v64, v73
    ds_read_u16_d16_hi v64, v98 offset:4096
    v_mul_f32 v85, v66, v71
    v_cvt_pk_bf16_f32 v74, v82, v83
    v_mul_f32 v86, v68, v69
    ds_read_u16_d16_hi v69, v98 offset:5184
    v_mul_f32 v87, v66, v72
    s_waitcnt lgkmcnt(9)
    v_mfma_f32_32x32x16_bf16 v[16:31], v[240:243], v[78:81], v[16:31]
    v_cvt_pk_bf16_f32 v75, v84, v85
    v_mul_f32 v88, v68, v70
    v_mul_f32 v89, v66, v73
    ds_read_u16_d16_hi v66, v98 offset:4224
    v_cvt_pk_bf16_f32 v76, v86, v87
    v_cvt_pk_bf16_f32 v77, v88, v89
    v_mul_f32 v82, v68, v72
    v_mul_f32 v83, v70, v70
    s_waitcnt lgkmcnt(8)
    v_mfma_f32_32x32x16_bf16 v[0:15], v[244:247], v[74:77], v[0:15]
    v_mul_f32 v84, v68, v73
    ds_read_u16_d16_hi v68, v98 offset:5120
    v_mul_f32 v85, v70, v71
    ds_read_u16_d16_hi v71, v99 offset:5312
    v_cvt_pk_bf16_f32 v78, v82, v83
    v_mul_f32 v86, v70, v72
    v_mul_f32 v87, v70, v73
    ds_read_u16_d16_hi v70, v98 offset:5248
    v_mfma_f32_32x32x16_bf16 v[16:31], v[116:119], v[74:77], v[16:31]
    ds_read_b128 v[116:119], v101 offset:4224
    v_cvt_pk_bf16_f32 v79, v84, v85
    v_mul_f32 v88, v72, v72
    v_mul_f32 v89, v72, v73
    ds_read_u16_d16_hi v72, v98 offset:6144
    ds_read_u16_d16_hi v73, v100 offset:6208
    v_cvt_pk_bf16_f32 v80, v86, v87
    v_cvt_pk_bf16_f32 v81, v88, v89
    s_nop 1
    s_waitcnt lgkmcnt(11)
    v_mfma_f32_32x32x16_bf16 v[0:15], v[248:251], v[78:81], v[0:15]
    s_waitcnt lgkmcnt(9)
    v_mfma_f32_32x32x16_bf16 v[16:31], v[252:255], v[78:81], v[16:31]
    v_mul_f32 v82, v48, v48
    v_mul_f32 v83, v48, v49
    v_mul_f32 v84, v48, v50
    v_mul_f32 v85, v48, v52
    v_cvt_pk_bf16_f32 v74, v82, v83
    v_mul_f32 v86, v50, v50
    v_mul_f32 v87, v48, v53
    v_cvt_pk_bf16_f32 v75, v84, v85
    v_mul_f32 v88, v50, v51
    v_mul_f32 v89, v48, v54
    v_cvt_pk_bf16_f32 v76, v86, v87
    v_cvt_pk_bf16_f32 v77, v88, v89
    v_mov_b32 v102, v103
    v_mov_b32 v103, v104
    v_mov_b32 v104, v105
    v_add_u32 v98, 0x1c00, v98
    v_add_u32 v99, 0x1c00, v99
    v_add_u32 v100, 0x1c00, v100
    v_mul_f32 v105, v0, v16
    v_mul_f32 v82, v1, v17
    v_fmac_f32 v105, v2, v18
    v_fmac_f32 v82, v3, v19
    v_fmac_f32 v105, v4, v20
    v_fmac_f32 v82, v5, v21
    v_fmac_f32 v105, v6, v22
    v_fmac_f32 v82, v7, v23
    v_fmac_f32 v105, v8, v24
    v_fmac_f32 v82, v9, v25
    v_fmac_f32 v105, v10, v26
    v_fmac_f32 v82, v11, v27
    v_fmac_f32 v105, v12, v28
    s_sub_u32 s59, s59, 1
    v_add_f32 v105, v105, v82
.p2align 3
L_row:
    ds_read_u16_d16_hi v49, v98 offset:64
    ds_read_u16_d16_hi v51, v99 offset:192
    v_mfma_f32_32x32x16_bf16 v[0:15], v[32:35], v[74:77], 0
    v_mul_f32 v82, v50, v52
    v_mul_f32 v83, v48, v55
    v_mul_f32 v84, v50, v53
    s_waitcnt lgkmcnt(15)
    v_mul_f32 v85, v48, v56
    v_cvt_pk_bf16_f32 v78, v82, v83
    v_mul_f32 v86, v50, v54
    v_mul_f32 v87, v52, v52
    v_mfma_f32_32x32x16_bf16 v[16:31], v[36:39], v[74:77], 0
    v_cvt_pk_bf16_f32 v79, v84, v85
    v_mul_f32 v88, v48, v57
    v_mul_f32 v89, v50, v55
    v_cvt_pk_bf16_f32 v80, v86, v87
    v_cvt_pk_bf16_f32 v81, v88, v89
    v_mul_f32 v82, v52, v53
    ds_read_u16_d16_hi v53, v98 offset:1088
    s_waitcnt lgkmcnt(13)
    v_mfma_f32_32x32x16_bf16 v[0:15], v[112:115], v[78:81], v[0:15]
    ds_read_b128 v[112:115], v101 offset:7392
    v_mul_f32 v83, v48, v58
    v_mul_f32 v84, v50, v56
    v_mul_f32 v85, v52, v54
    v_cvt_pk_bf16_f32 v74, v82, v83
    v_mul_f32 v86, v48, v59
    v_mul_f32 v87, v50, v57
    v_mfma_f32_32x32x16_bf16 v[16:31], v[40:43], v[78:81], v[16:31]
    v_cvt_pk_bf16_f32 v75, v84, v85
    v_mul_f32 v88, v48, v60
    v_mul_f32 v89, v50, v58
    v_cvt_pk_bf16_f32 v76, v86, v87
    v_cvt_pk_bf16_f32 v77, v88, v89
    v_mul_f32 v82, v52, v56
    v_mul_f32 v83, v54, v54
    v_mfma_f32_32x32x16_bf16 v[0:15], v[44:47], v[74:77], v[0:15]
    v_mul_f32 v84, v48, v61
    v_mul_f32 v85, v50, v59
    v_cvt_pk_bf16_f32 v78, v82, v83
    v_mul_f32 v86, v52, v57
    v_mul_f32 v87, v54, v55
    ds_read_u16_d16_hi v55, v99 offset:1216
    v_mfma_f32_32x32x16_bf16 v[16:31], v[120:123], v[74:77], v[16:31]
    v_cvt_pk_bf16_f32 v79, v84, v85
    s_waitcnt lgkmcnt(14)
    v_mul_f32 v88, v48, v62
    v_mul_f32 v89, v50, v60
    v_cvt_pk_bf16_f32 v80, v86, v87
    v_cvt_pk_bf16_f32 v81, v88, v89
    v_mul_f32 v82, v52, v58
    v_mul_f32 v83, v54, v56
    v_mfma_f32_32x32x16_bf16 v[0:15], v[124:127], v[78:81], v[0:15]
    v_mul_f32 v84, v48, v63
    v_mul_f32 v85, v50, v61
    v_cvt_pk_bf16_f32 v74, v82, v83
    v_mul_f32 v86, v52, v59
    v_mul_f32 v87, v54, v57
    v_cvt_pk_bf16_f32 v75, v84, v85
    v_mfma_f32_32x32x16_bf16 v[16:31], v[128:131], v[78:81], v[16:31]
    s_waitcnt lgkmcnt(13)
    v_mul_f32 v88, v48, v64
    v_mul_f32 v89, v50, v62
    v_cvt_pk_bf16_f32 v76, v86, v87
    v_cvt_pk_bf16_f32 v77, v88, v89
    v_mul_f32 v82, v52, v60
    v_mul_f32 v83, v54, v58
    s_waitcnt lgkmcnt(7)
    v_mfma_f32_32x32x16_bf16 v[0:15], v[116:119], v[74:77], v[0:15]
    ds_read_b128 v[116:119], v101 offset:10560
    v_mul_f32 v84, v56, v56
    v_mul_f32 v85, v48, v65
    v_cvt_pk_bf16_f32 v78, v82, v83
    v_mul_f32 v86, v50, v63
    v_mul_f32 v87, v52, v61
    v_cvt_pk_bf16_f32 v79, v84, v85
    v_mfma_f32_32x32x16_bf16 v[16:31], v[132:135], v[74:77], v[16:31]
    v_mul_f32 v88, v54, v59
    v_mul_f32 v89, v56, v57
    ds_read_u16_d16_hi v57, v98 offset:2112
    v_cvt_pk_bf16_f32 v80, v86, v87
    v_cvt_pk_bf16_f32 v81, v88, v89
    v_mul_f32 v82, v48, v66
    v_mul_f32 v83, v50, v64
    v_mfma_f32_32x32x16_bf16 v[0:15], v[136:139], v[78:81], v[0:15]
    v_mul_f32 v84, v52, v62
    v_mul_f32 v85, v54, v60
    v_cvt_pk_bf16_f32 v74, v82, v83
    v_mul_f32 v86, v56, v58
    v_mul_f32 v87, v48, v67
    v_cvt_pk_bf16_f32 v75, v84, v85
    v_mfma_f32_32x32x16_bf16 v[16:31], v[140:143], v[78:81], v[16:31]
    v_mul_f32 v88, v50, v65
    v_mul_f32 v89, v52, v63
    v_cvt_pk_bf16_f32 v76, v86, v87
    v_cvt_pk_bf16_f32 v77, v88, v89
    v_mul_f32 v82, v54, v61
    v_mul_f32 v83, v48, v68
    v_mfma_f32_32x32x16_bf16 v[0:15], v[144:147], v[74:77], v[0:15]
    v_mul_f32 v84, v50, v66
    v_mul_f32 v85, v52, v64
    v_cvt_pk_bf16_f32 v78, v82, v83
    v_mul_f32 v86, v54, v62
    v_mul_f32 v87, v56, v60
    v_cvt_pk_bf16_f32 v79, v84, v85
    v_mfma_f32_32x32x16_bf16 v[16:31], v[148:151], v[74:77], v[16:31]
    v_mul_f32 v88, v58, v58
    v_mul_f32 v89, v48, v69
    v_cvt_pk_bf16_f32 v80, v86, v87
    v_cvt_pk_bf16_f32 v81, v88, v89
    v_mul_f32 v82, v50, v67
    v_mul_f32 v83, v52, v65
    s_waitcnt lgkmcnt(3)
    v_mfma_f32_32x32x16_bf16 v[0:15], v[112:115], v[78:81], v[0:15]
    ds_read_b128 v[112:115], v101 offset:38016
    v_mul_f32 v84, v54, v63
    v_mul_f32 v85, v56, v61
    v_cvt_pk_bf16_f32 v74, v82, v83
    v_mul_f32 v86, v58, v59
    ds_read_u16_d16_hi v59, v99 offset:2240
    v_mul_f32 v87, v48, v70
    v_mfma_f32_32x32x16_bf16 v[16:31], v[152:155], v[78:81], v[16:31]
    v_cvt_pk_bf16_f32 v75, v84, v85
    v_mul_f32 v88, v50, v68
    v_mul_f32 v89, v52, v66
    v_cvt_pk_bf16_f32 v76, v86, v87
    v_cvt_pk_bf16_f32 v77, v88, v89
    v_mul_f32 v82, v54, v64
    v_mul_f32 v83, v56, v62
    v_mfma_f32_32x32x16_bf16 v[0:15], v[156:159], v[74:77], v[0:15]
    v_mul_f32 v84, v58, v60
    v_mul_f32 v85, v48, v71
    v_cvt_pk_bf16_f32 v78, v82, v83
    v_mul_f32 v86, v50, v69
    v_mul_f32 v87, v52, v67
    v_cvt_pk_bf16_f32 v79, v84, v85
    v_mfma_f32_32x32x16_bf16 v[16:31], v[160:163], v[74:77], v[16:31]
    v_mul_f32 v88, v54, v65
    v_mul_f32 v89, v56, v63
    v_cvt_pk_bf16_f32 v80, v86, v87
    v_cvt_pk_bf16_f32 v81, v88, v89
    v_mul_f32 v82, v58, v61
    v_mul_f32 v83, v48, v72
    v_mfma_f32_32x32x16_bf16 v[0:15], v[164:167], v[78:81], v[0:15]
    v_mul_f32 v84, v50, v70
    v_mul_f32 v85, v52, v68
    v_cvt_pk_bf16_f32 v74, v82, v83
    v_mul_f32 v86, v54, v66
    v_mul_f32 v87, v56, v64
    v_cvt_pk_bf16_f32 v75, v84, v85
    v_mfma_f32_32x32x16_bf16 v[16:31], v[168:171], v[78:81], v[16:31]
    v_mul_f32 v88, v58, v62
    v_mul_f32 v89, v60, v60
    v_cvt_pk_bf16_f32 v76, v86, v87
    v_cvt_pk_bf16_f32 v77, v88, v89
    v_cvt_pk_bf16_f32 v90, v48, v50
    v_cvt_pk_bf16_f32 v91, v52, v54
    s_waitcnt lgkmcnt(3)
    v_mfma_f32_32x32x16_bf16 v[0:15], v[116:119], v[74:77], v[0:15]
    ds_read_b128 v[116:119], v101 offset:15840
    v_cvt_pk_bf16_f32 v92, v56, v58
    v_cvt_pk_bf16_f32 v93, v60, v62
    v_cvt_pk_bf16_f32 v94, v64, v66
    v_cvt_pk_bf16_f32 v95, v68, v70
    v_cvt_pk_bf16_f32 v96, v72, 1.0
    v_mul_f32 v82, v48, v73
    ds_read_u16_d16_hi v48, v98 offset:0
    v_mul_f32 v83, v50, v71
    v_mul_f32 v84, v52, v69
    v_mul_f32 v85, v54, v67
    v_mfma_f32_32x32x16_bf16 v[16:31], v[172:175], v[74:77], v[16:31]
    v_cvt_pk_bf16_f32 v78, v82, v83
    v_mul_f32 v86, v56, v65
    v_mul_f32 v87, v58, v63
    v_cvt_pk_bf16_f32 v79, v84, v85
    v_mul_f32 v88, v60, v61
    ds_read_u16_d16_hi v61, v98 offset:3136
    v_mul_f32 v89, v50, v72
    v_cvt_pk_bf16_f32 v80, v86, v87
    v_cvt_pk_bf16_f32 v81, v88, v89
    v_mul_f32 v82, v52, v70
    v_mul_f32 v83, v54, v68
    v_mfma_f32_32x32x16_bf16 v[0:15], v[176:179], v[78:81], v[0:15]
    v_mul_f32 v84, v56, v66
    v_mul_f32 v85, v58, v64
    v_cvt_pk_bf16_f32 v74, v82, v83
    v_mul_f32 v86, v60, v62
    v_mul_f32 v87, v50, v73
    ds_read_u16_d16_hi v50, v98 offset:128
    v_mfma_f32_32x32x16_bf16 v[16:31], v[180:183], v[78:81], v[16:31]
    v_cvt_pk_bf16_f32 v75, v84, v85
    v_mul_f32 v88, v52, v71
    v_mul_f32 v89, v54, v69
    v_cvt_pk_bf16_f32 v76, v86, v87
    v_cvt_pk_bf16_f32 v77, v88, v89
    v_mul_f32 v82, v56, v67
    v_mul_f32 v83, v58, v65
    v_mfma_f32_32x32x16_bf16 v[0:15], v[184:187], v[74:77], v[0:15]
    v_mul_f32 v84, v52, v72
    v_mul_f32 v85, v54, v70
    v_cvt_pk_bf16_f32 v78, v82, v83
    v_mul_f32 v86, v56, v68
    v_mul_f32 v87, v58, v66
    v_cvt_pk_bf16_f32 v79, v84, v85
    s_waitcnt lgkmcnt(5)
    v_mfma_f32_32x32x16_bf16 v[16:31], v[112:115], v[74:77], v[16:31]
    ds_read_b128 v[112:115], v101 offset:19008
    v_mul_f32 v88, v60, v64
    v_mul_f32 v89, v62, v62
    v_cvt_pk_bf16_f32 v80, v86, v87
    v_cvt_pk_bf16_f32 v81, v88, v89
    v_mul_f32 v82, v52, v73
    ds_read_u16_d16_hi v52, v98 offset:1024
    v_mfma_f32_32x32x16_bf16 v[0:15], v[188:191], v[78:81], v[0:15]
    v_mul_f32 v83, v54, v71
    v_mul_f32 v84, v56, v69
    v_mul_f32 v85, v58, v67
    v_cvt_pk_bf16_f32 v74, v82, v83
    v_mul_f32 v86, v60, v65
    v_mul_f32 v87, v62, v63
    ds_read_u16_d16_hi v63, v99 offset:3264
    v_mfma_f32_32x32x16_bf16 v[16:31], v[192:195], v[78:81], v[16:31]
    v_cvt_pk_bf16_f32 v75, v84, v85
    v_mul_f32 v88, v54, v72
    v_mul_f32 v89, v56, v70
    v_cvt_pk_bf16_f32 v76, v86, v87
    v_cvt_pk_bf16_f32 v77, v88, v89
    v_mul_f32 v82, v58, v68
    v_mul_f32 v83, v60, v66
    v_mfma_f32_32x32x16_bf16 v[0:15], v[196:199], v[74:77], v[0:15]
    v_mul_f32 v84, v62, v64
    v_mul_f32 v85, v54, v73
    ds_read_u16_d16_hi v54, v98 offset:1152
    v_cvt_pk_bf16_f32 v78, v82, v83
    v_mfma_f32_32x32x16_bf16 v[16:31], v[200:203], v[74:77], v[16:31]
    v_mul_f32 v86, v56, v71
    v_mul_f32 v87, v58, v69
    v_cvt_pk_bf16_f32 v79, v84, v85
    v_mul_f32 v88, v60, v67
    v_mfma_f32_32x32x16_bf16 v[16:31], v[204:207], v[90:93], v[16:31]
    v_mul_f32 v89, v62, v65
    v_cvt_pk_bf16_f32 v80, v86, v87
    v_cvt_pk_bf16_f32 v81, v88, v89
    v_mul_f32 v82, v56, v72
    v_mul_f32 v83, v58, v70
    s_waitcnt lgkmcnt(7)
    v_mfma_f32_32x32x16_bf16 v[0:15], v[116:119], v[78:81], v[0:15]
    ds_read_b128 v[116:119], v101 offset:46464
    v_mul_f32 v84, v60, v68
    v_mul_f32 v85, v62, v66
    v_cvt_pk_bf16_f32 v74, v82, v83
    v_mul_f32 v86, v64, v64
    v_mul_f32 v87, v56, v73
    ds_read_u16_d16_hi v56, v98 offset:2048
    v_mfma_f32_32x32x16_bf16 v[16:31], v[208:211], v[78:81], v[16:31]
    v_cvt_pk_bf16_f32 v75, v84, v85
    v_mul_f32 v88, v58, v71
    v_mul_f32 v89, v60, v69
    v_cvt_pk_bf16_f32 v76, v86, v87
    v_cvt_pk_bf16_f32 v77, v88, v89
    s_cmp_gt_u32 s59, 2
    s_cbranch_scc1 L_nomb_9
    s_cmp_eq_u32 s59, 1
    s_cbranch_scc1 L_mb1_10
    global_load_dword v106, v107, s[38:39] offset:64 sc1
    s_branch L_nomb_9
L_mbf_11:
    global_load_dword v106, v107, s[38:39] offset:64 sc1
    s_sub_u32 s50, s50, 1
    s_cbranch_scc1 L_end
L_mb1_10:
    s_waitcnt vmcnt(0)
    v_readfirstlane_b32 s51, v106
    s_cmp_ge_u32 s51, 26
    s_cbranch_scc0 L_mbf_11
    buffer_load_dwordx4 v[106:109], v110, s[32:35], s62 offen sc1
L_nomb_9:
    v_mul_f32 v82, v62, v67
    v_mul_f32 v83, v64, v65
    v_mfma_f32_32x32x16_bf16 v[0:15], v[212:215], v[74:77], v[0:15]
    ds_read_u16_d16_hi v65, v98 offset:4160
    v_mul_f32 v84, v58, v72
    v_mul_f32 v85, v60, v70
    v_cvt_pk_bf16_f32 v78, v82, v83
    v_mul_f32 v86, v62, v68
    v_mul_f32 v87, v64, v66
    v_cvt_pk_bf16_f32 v79, v84, v85
    v_mfma_f32_32x32x16_bf16 v[16:31], v[216:219], v[74:77], v[16:31]
    v_mul_f32 v88, v58, v73
    ds_read_u16_d16_hi v58, v98 offset:2176
    v_mul_f32 v89, v60, v71
    v_cvt_pk_bf16_f32 v80, v86, v87
    v_cvt_pk_bf16_f32 v81, v88, v89
    v_mul_f32 v82, v62, v69
    v_mul_f32 v83, v60, v72
    v_mfma_f32_32x32x16_bf16 v[0:15], v[220:223], v[78:81], v[0:15]
    v_mul_f32 v84, v62, v70
    v_mul_f32 v85, v64, v68
    v_cvt_pk_bf16_f32 v74, v82, v83
    v_mul_f32 v86, v66, v66
    v_mul_f32 v87, v60, v73
    ds_read_u16_d16_hi v60, v98 offset:3072
    v_mfma_f32_32x32x16_bf16 v[16:31], v[224:227], v[78:81], v[16:31]
    v_cvt_pk_bf16_f32 v75, v84, v85
    v_mul_f32 v88, v62, v71
    v_mul_f32 v89, v64, v69
    v_cvt_pk_bf16_f32 v76, v86, v87
    v_cvt_pk_bf16_f32 v77, v88, v89
    v_mul_f32 v82, v66, v67
    ds_read_u16_d16_hi v67, v99 offset:4288
    s_waitcnt lgkmcnt(9)
    v_mfma_f32_32x32x16_bf16 v[0:15], v[112:115], v[74:77], v[0:15]
    ds_read_b128 v[112:115], v101 offset:1056
    v_mul_f32 v83, v62, v72
    v_mul_f32 v84, v64, v70
    v_mul_f32 v85, v66, v68
    v_cvt_pk_bf16_f32 v78, v82, v83
    v_mfma_f32_32x32x16_bf16 v[16:31], v[228:231], v[74:77], v[16:31]
    v_mul_f32 v86, v62, v73
    ds_read_u16_d16_hi v62, v98 offset:3200
    v_mul_f32 v87, v64, v71
    v_cvt_pk_bf16_f32 v79, v84, v85
    v_mul_f32 v88, v66, v69
    v_mfma_f32_32x32x16_bf16 v[16:31], v[232:235], v[94:97], v[16:31]
    v_mul_f32 v89, v64, v72
    v_cvt_pk_bf16_f32 v80, v86, v87
    v_cvt_pk_bf16_f32 v81, v88, v89
    v_mul_f32 v82, v66, v70
    v_mul_f32 v83, v68, v68
    v_mfma_f32_32x32x16_bf16 v[0:15], v[236:239], v[78:81], v[0:15]
    v_mul_f32 v84, v64, v73
    ds_read_u16_d16_hi v64, v98 offset:4096
    v_mul_f32 v85, v66, v71
    v_cvt_pk_bf16_f32 v74, v82, v83
    v_mul_f32 v86, v68, v69
    ds_read_u16_d16_hi v69, v98 offset:5184
    v_mul_f32 v87, v66, v72
    v_mfma_f32_32x32x16_bf16 v[16:31], v[240:243], v[78:81], v[16:31]
    v_cvt_pk_bf16_f32 v75, v84, v85
    v_mul_f32 v88, v68, v70
    v_mul_f32 v89, v66, v73
    ds_read_u16_d16_hi v66, v98 offset:4224
    v_cvt_pk_bf16_f32 v76, v86, v87
    v_cvt_pk_bf16_f32 v77, v88, v89
    v_mul_f32 v82, v68, v72
    v_mul_f32 v83, v70, v70
    v_mfma_f32_32x32x16_bf16 v[0:15], v[244:247], v[74:77], v[0:15]
    v_mul_f32 v84, v68, v73
    ds_read_u16_d16_hi v68, v98 offset:5120
    v_mul_f32 v85, v70, v71
    ds_read_u16_d16_hi v71, v99 offset:5312
    v_cvt_pk_bf16_f32 v78, v82, v83
    v_mul_f32 v86, v70, v72
    v_mul_f32 v87, v70, v73
    ds_read_u16_d16_hi v70, v98 offset:5248
    s_waitcnt lgkmcnt(13)
    v_mfma_f32_32x32x16_bf16 v[16:31], v[116:119], v[74:77], v[16:31]
    ds_read_b128 v[116:119], v101 offset:4224
    v_cvt_pk_bf16_f32 v79, v84, v85
    v_mul_f32 v88, v72, v72
    v_mul_f32 v89, v72, v73
    ds_read_u16_d16_hi v72, v98 offset:6144
    ds_read_u16_d16_hi v73, v100 offset:6208
    v_cvt_pk_bf16_f32 v80, v86, v87
    v_cvt_pk_bf16_f32 v81, v88, v89
    s_nop 1
    v_mfma_f32_32x32x16_bf16 v[0:15], v[248:251], v[78:81], v[0:15]
    v_mfma_f32_32x32x16_bf16 v[16:31], v[252:255], v[78:81], v[16:31]
    v_mul_f32 v82, v48, v48
    v_mul_f32 v83, v48, v49
    v_mul_f32 v84, v48, v50
    v_mul_f32 v85, v48, v52
    v_cvt_pk_bf16_f32 v74, v82, v83
    v_mul_f32 v86, v50, v50
    v_mul_f32 v87, v48, v53
    v_cvt_pk_bf16_f32 v75, v84, v85
    v_mul_f32 v88, v50, v51
    v_mul_f32 v89, v48, v54
    v_cvt_pk_bf16_f32 v76, v86, v87
    v_cvt_pk_bf16_f32 v77, v88, v89
    v_mov_b32 v102, v103
    v_mov_b32 v103, v104
    v_mov_b32 v104, v105
    v_add_u32 v98, 0x1c00, v98
    v_add_u32 v99, 0x1c00, v99
    v_add_u32 v100, 0x1c00, v100
    v_mul_f32 v105, v0, v16
    v_mul_f32 v82, v1, v17
    v_fmac_f32 v105, v2, v18
    v_fmac_f32 v82, v3, v19
    v_fmac_f32 v105, v4, v20
    v_fmac_f32 v82, v5, v21
    v_fmac_f32 v105, v6, v22
    v_fmac_f32 v82, v7, v23
    v_fmac_f32 v105, v8, v24
    v_fmac_f32 v82, v9, v25
    v_fmac_f32 v105, v10, v26
    v_fmac_f32 v82, v11, v27
    v_fmac_f32 v105, v12, v28
    s_sub_u32 s59, s59, 1
    v_add_f32 v105, v105, v82
    s_cmp_lg_u32 s59, 1
    s_cbranch_scc1 L_noflip
    s_setprio 0
L_noflip:
    s_cmp_lg_u32 s59, 0
    s_cbranch_scc1 L_row
    v_mov_b32 v4, s63
L_mbw:
    s_waitcnt vmcnt(0)
    v_max3_u32 v1, v106, v107, v108
    v_max_u32 v1, v1, v109
    v_cmp_eq_u32 vcc, -1, v1
    s_nop 1
    s_cmp_eq_u64 vcc, 0
    s_cbranch_scc1 L_mbok
    s_add_u32 s59, s59, 1
    s_and_b32 s51, s59, 31
    s_cselect_b32 s51, s62, s61
    buffer_load_dwordx4 v[106:109], v110, s[32:35], s51 offen sc1
    s_sub_u32 s50, s50, 1
    s_cbranch_scc0 L_mbw
    s_endpgm
L_mbok:
    v_add_f32 v102, v102, v106
    v_add_f32 v103, v103, v107
    v_add_f32 v104, v104, v108
    v_add_f32 v105, v105, v109
    v_add_f32_dpp v102, v102, v102 quad_perm:[1,0,3,2] row_mask:0xf bank_mask:0xf
    v_add_f32_dpp v103, v103, v103 quad_perm:[1,0,3,2] row_mask:0xf bank_mask:0xf
    v_add_f32_dpp v104, v104, v104 quad_perm:[1,0,3,2] row_mask:0xf bank_mask:0xf
    v_add_f32_dpp v105, v105, v105 quad_perm:[1,0,3,2] row_mask:0xf bank_mask:0xf
    v_add_f32_dpp v102, v102, v102 quad_perm:[2,3,0,1] row_mask:0xf bank_mask:0xf
    v_add_f32_dpp v103, v103, v103 quad_perm:[2,3,0,1] row_mask:0xf bank_mask:0xf
    v_add_f32_dpp v104, v104, v104 quad_perm:[2,3,0,1] row_mask:0xf bank_mask:0xf
    v_add_f32_dpp v105, v105, v105 quad_perm:[2,3,0,1] row_mask:0xf bank_mask:0xf
    v_add_f32_dpp v102, v102, v102 row_half_mirror row_mask:0xf bank_mask:0xf
    v_add_f32_dpp v103, v103, v103 row_half_mirror row_mask:0xf bank_mask:0xf
    v_add_f32_dpp v104, v104, v104 row_half_mirror row_mask:0xf bank_mask:0xf
    v_add_f32_dpp v105, v105, v105 row_half_mirror row_mask:0xf bank_mask:0xf
    v_add_f32_dpp v102, v102, v102 row_mirror row_mask:0xf bank_mask:0xf
    v_add_f32_dpp v103, v103, v103 row_mirror row_mask:0xf bank_mask:0xf
    v_add_f32_dpp v104, v104, v104 row_mirror row_mask:0xf bank_mask:0xf
    v_add_f32_dpp v105, v105, v105 row_mirror row_mask:0xf bank_mask:0xf
    v_add_f32_dpp v102, v102, v102 row_bcast:15 row_mask:0xa bank_mask:0xf
    v_add_f32_dpp v103, v103, v103 row_bcast:15 row_mask:0xa bank_mask:0xf
    v_add_f32_dpp v104, v104, v104 row_bcast:15 row_mask:0xa bank_mask:0xf
    v_add_f32_dpp v105, v105, v105 row_bcast:15 row_mask:0xa bank_mask:0xf
    v_add_f32_dpp v102, v102, v102 row_bcast:31 row_mask:0xc bank_mask:0xf
    v_add_f32_dpp v103, v103, v103 row_bcast:31 row_mask:0xc bank_mask:0xf
    v_add_f32_dpp v104, v104, v104 row_bcast:31 row_mask:0xc bank_mask:0xf
    v_add_f32_dpp v105, v105, v105 row_bcast:31 row_mask:0xc bank_mask:0xf
    v_add_f32 v102, s40, v102
    v_add_f32 v103, s40, v103
    v_add_f32 v104, s40, v104
    v_add_f32 v105, s40, v105
    v_cvt_pk_bf16_f32 v2, v102, v103
    v_cvt_pk_bf16_f32 v3, v104, v105
    s_mov_b32 exec_lo, 0
    s_mov_b32 exec_hi, 0x80000000
    global_store_dwordx2 v4, v[2:3], s[36:37] offset:-6
L_std:
L_end:
    s_endpgm
.p2align 6
L_dnn:
    s_mov_b64 s[24:25], s[62:63]
    s_mov_b32 s26, 1664
    s_mov_b32 s27, 0x20000
    s_mov_b64 s[8:9], s[54:55]
    s_mov_b32 s10, 6400000
    s_mov_b32 s11, 0x20000
    s_mov_b64 s[28:29], s[64:65]
    s_mov_b32 s30, 1664
    s_mov_b32 s31, 0x20000
    s_mov_b32 s34, 305408
    s_mov_b32 s35, 0x20000
    s_mov_b32 s50, 0x40000
    s_mul_i32 s46, s44, 416
    s_mov_b32 s54, s46
    s_and_b32 s58, s42, 3
    s_lshl_b32 s52, s42, 1
    s_sub_u32 s52, s52, 4
    s_add_u32 s53, s52, 1
    s_cmp_lt_u32 s42, 4
    s_cselect_b32 s55, s42, s52
    s_cselect_b32 s57, 12, s53
    s_lshl_b32 s55, s55, 10
    s_lshl_b32 s57, s57, 10
    s_lshl_b32 s56, s42, 10
    s_add_u32 s56, s56, 13312
    s_lshr_b32 s52, s42, 2
    s_mul_i32 s52, s52, 224
    s_add_u32 s46, s46, s52
    s_movk_i32 s53, 1248
    s_movk_i32 s59, 6656
    v_add_u32 v3, s55, v165
    v_lshlrev_b32 v4, 4, v3
    v_mul_hi_u32_u24 v4, 0x9d89e, v4
    v_bfe_u32 v5, v4, 2, 1
    v_bfe_i32 v6, v4, 3, 1
    v_add_u32 v5, v5, v6
    v_mad_i32_i24 v5, v5, s59, v3
    v_mad_u32_u24 v128, v4, s53, v5
    v_add_u32 v3, s57, v165
    v_lshlrev_b32 v4, 4, v3
    v_mul_hi_u32_u24 v4, 0x9d89e, v4
    v_bfe_u32 v5, v4, 2, 1
    v_bfe_i32 v6, v4, 3, 1
    v_add_u32 v5, v5, v6
    v_mad_i32_i24 v5, v5, s59, v3
    v_mad_u32_u24 v129, v4, s53, v5
    v_lshrrev_b32 v2, 2, v0
    v_mul_u32_u24 v2, 104, v2
    s_add_u32 s47, s47, 150528
    v_add_u32 v139, s47, v2
    v_lshrrev_b32 v2, 5, v0
    v_mul_u32_u24 v3, 3, v2
    v_xor_b32 v3, v3, v0
    v_and_b32 v3, 3, v3
    v_lshlrev_b32 v136, 4, v3
    s_waitcnt vmcnt(2)
    ds_read2_b64 v[100:103], v139 offset0:0 offset1:1
    ds_read2_b64 v[104:107], v139 offset0:2 offset1:3
    ds_read2_b64 v[108:111], v139 offset0:4 offset1:5
    ds_read2_b64 v[112:115], v139 offset0:6 offset1:7
    ds_read2_b64 v[116:119], v139 offset0:8 offset1:9
    ds_read2_b64 v[120:123], v139 offset0:10 offset1:11
    ds_read_b64 v[124:125], v139 offset:96
    s_cmp_ge_u32 s42, 2
    s_cbranch_scc1 L_nobw
    s_mul_i32 s51, s44, 416
    s_cmp_eq_u32 s42, 0
    s_cselect_b64 s[28:29], s[24:25], s[28:29]
    s_mov_b32 m0, s47
    s_mov_b64 exec, 0xfffffff
    s_waitcnt lgkmcnt(0)
    buffer_load_dwordx4 v165, s[28:31], s51 offen lds
    s_mov_b64 exec, -1
L_nobw:
    s_waitcnt lgkmcnt(6)
    s_add_u32 m0, s56, 0
    v_lshl_add_u32 v100, v100, 6, v136
    buffer_load_dwordx4 v100, s[8:11], 0 offen lds
    s_cmp_ge_u32 s42, 4
    s_cselect_b32 s51, 0, s58
    s_cmp_lg_u32 s51, 0
    s_cbranch_scc1 L_np_13
    s_add_u32 m0, s57, 0
    s_nop 0
    buffer_load_dwordx4 v129, s[12:15], s54 offen lds
L_np_13:
    s_add_u32 m0, s55, 0
    s_nop 0
    buffer_load_dwordx4 v128, s[12:15], s54 offen lds
    v_lshrrev_b32 v1, 4, v0
    s_add_u32 s53, s52, 150528
    v_lshl_add_u32 v138, v1, 3, s53
    v_bfe_u32 v3, v0, 3, 1
    v_mul_u32_u24 v3, 3, v3
    v_xor_b32 v3, v3, v1
    v_and_b32 v4, 15, v0
    v_lshlrev_b32 v4, 6, v4
    v_lshl_add_u32 v3, v3, 4, v4
    s_and_b32 s53, s42, 3
    s_lshl_b32 s53, s53, 11
    s_add_u32 s53, s53, 13312
    v_add_u32 v133, s53, v3
    v_bfe_u32 v3, v0, 2, 3
    v_lshl_add_u32 v2, v2, 4, v3
    v_mul_u32_u24 v2, 0x1a0, v2
    v_and_b32 v3, 3, v0
    v_lshl_add_u32 v2, v3, 3, v2
    v_add_u32 v130, s52, v2
    v_add_u32 v134, 64512, v133
    v_add_u32 v131, 64512, v130
    v_add_u32 v135, 129024, v133
    v_add_u32 v132, 129024, v130
    v_mov_b32 v137, v0
    s_add_u32 m0, s56, 21504
    v_lshl_add_u32 v101, v101, 6, v136
    buffer_load_dwordx4 v101, s[8:11], 0 offen lds
    s_add_u32 s54, s54, 53248
    s_cmp_ge_u32 s42, 4
    s_cselect_b32 s51, 1, s58
    s_cmp_lg_u32 s51, 1
    s_cbranch_scc1 L_np_14
    s_add_u32 m0, s57, 21504
    s_nop 0
    buffer_load_dwordx4 v129, s[12:15], s54 offen lds
L_np_14:
    s_add_u32 m0, s55, 21504
    s_nop 0
    buffer_load_dwordx4 v128, s[12:15], s54 offen lds
    s_cmp_ge_u32 s42, 4
    s_cbranch_scc1 L_dnn6
    s_waitcnt vmcnt(2)
    s_barrier
    ds_read_b64 v[140:141], v138 offset:0
    ds_read_b64 v[142:143], v138 offset:32
    ds_read_b64 v[144:145], v138 offset:64
    ds_read_b64 v[146:147], v138 offset:96
    ds_read_b64 v[148:149], v138 offset:128
    ds_read_b64 v[150:151], v138 offset:160
    ds_read_b64 v[152:153], v138 offset:192
    ds_read_b128 v[84:87], v133 offset:0
    ds_read_b128 v[88:91], v133 offset:1024
    ds_read_b64_tr_b16 v[56:57], v130 offset:0
    ds_read_b64_tr_b16 v[58:59], v130 offset:3328
    ds_read_b64_tr_b16 v[60:61], v130 offset:32
    ds_read_b64_tr_b16 v[62:63], v130 offset:3360
    ds_read_b64_tr_b16 v[64:65], v130 offset:64
    ds_read_b64_tr_b16 v[66:67], v130 offset:3392
    ds_read_b64_tr_b16 v[68:69], v130 offset:96
    ds_read_b64_tr_b16 v[70:71], v130 offset:3424
    ds_read_b64_tr_b16 v[72:73], v130 offset:128
    ds_read_b64_tr_b16 v[74:75], v130 offset:3456
    ds_read_b64_tr_b16 v[76:77], v130 offset:160
    ds_read_b64_tr_b16 v[78:79], v130 offset:3488
    ds_read_b64_tr_b16 v[80:81], v130 offset:192
    ds_read_b64_tr_b16 v[82:83], v130 offset:3520
    s_waitcnt lgkmcnt(15)
    v_lshlrev_b32 v0, 16, v140
    v_and_b32 v1, 0xffff0000, v140
    v_lshlrev_b32 v2, 16, v141
    v_and_b32 v3, 0xffff0000, v141
    v_lshlrev_b32 v8, 16, v142
    v_and_b32 v9, 0xffff0000, v142
    v_lshlrev_b32 v10, 16, v143
    v_and_b32 v11, 0xffff0000, v143
    v_lshlrev_b32 v16, 16, v144
    v_and_b32 v17, 0xffff0000, v144
    v_lshlrev_b32 v18, 16, v145
    v_and_b32 v19, 0xffff0000, v145
    v_lshlrev_b32 v24, 16, v146
    v_and_b32 v25, 0xffff0000, v146
    v_lshlrev_b32 v26, 16, v147
    v_and_b32 v27, 0xffff0000, v147
    v_lshlrev_b32 v32, 16, v148
    v_and_b32 v33, 0xffff0000, v148
    v_lshlrev_b32 v34, 16, v149
    v_and_b32 v35, 0xffff0000, v149
    v_lshlrev_b32 v40, 16, v150
    v_and_b32 v41, 0xffff0000, v150
    v_lshlrev_b32 v42, 16, v151
    v_and_b32 v43, 0xffff0000, v151
    v_lshlrev_b32 v48, 16, v152
    v_and_b32 v49, 0xffff0000, v152
    v_lshlrev_b32 v50, 16, v153
    v_and_b32 v51, 0xffff0000, v153
    s_add_u32 m0, s56, 43008
    v_lshl_add_u32 v102, v102, 6, v136
    buffer_load_dwordx4 v102, s[8:11], 0 offen lds
    s_add_u32 s54, s54, 53248
    s_cmp_lg_u32 s58, 2
    s_cbranch_scc1 L_np_15
    s_add_u32 m0, s57, 43008
    s_nop 0
    buffer_load_dwordx4 v129, s[12:15], s54 offen lds
L_np_15:
    s_add_u32 m0, s55, 43008
    s_nop 0
    buffer_load_dwordx4 v128, s[12:15], s54 offen lds
    s_waitcnt vmcnt(2)
    s_barrier
    s_add_u32 m0, s56, 64512
    v_lshl_add_u32 v103, v103, 6, v136
    buffer_load_dwordx4 v103, s[8:11], 0 offen lds
    s_add_u32 s54, s54, 53248
    s_cmp_lg_u32 s58, 3
    s_cbranch_scc1 L_np_16
    s_add_u32 m0, s57, 64512
    s_nop 0
    buffer_load_dwordx4 v129, s[12:15], s54 offen lds
L_np_16:
    s_add_u32 m0, s55, 64512
    s_nop 0
    buffer_load_dwordx4 v128, s[12:15], s54 offen lds
    s_waitcnt lgkmcnt(12)
    v_mfma_f32_16x16x32_bf16 v[4:7], v[56:59], v[88:91], v[0:3]
    v_mfma_f32_16x16x32_bf16 v[0:3], v[56:59], v[84:87], v[0:3]
    ds_read_b64_tr_b16 v[56:57], v130 offset:21504
    s_waitcnt lgkmcnt(11)
    v_mfma_f32_16x16x32_bf16 v[12:15], v[60:63], v[88:91], v[8:11]
    ds_read_b64_tr_b16 v[58:59], v130 offset:24832
    v_mfma_f32_16x16x32_bf16 v[8:11], v[60:63], v[84:87], v[8:11]
    ds_read_b64_tr_b16 v[60:61], v130 offset:21536
    ds_read_b128 v[92:95], v133 offset:21504
    ds_read_b128 v[96:99], v133 offset:22528
    s_waitcnt lgkmcnt(13)
    v_mfma_f32_16x16x32_bf16 v[20:23], v[64:67], v[88:91], v[16:19]
    ds_read_b64_tr_b16 v[62:63], v130 offset:24864
    v_mfma_f32_16x16x32_bf16 v[16:19], v[64:67], v[84:87], v[16:19]
    ds_read_b64_tr_b16 v[64:65], v130 offset:21568
    s_waitcnt lgkmcnt(13)
    v_mfma_f32_16x16x32_bf16 v[28:31], v[68:71], v[88:91], v[24:27]
    ds_read_b64_tr_b16 v[66:67], v130 offset:24896
    v_mfma_f32_16x16x32_bf16 v[24:27], v[68:71], v[84:87], v[24:27]
    ds_read_b64_tr_b16 v[68:69], v130 offset:21600
    s_waitcnt lgkmcnt(13)
    v_mfma_f32_16x16x32_bf16 v[36:39], v[72:75], v[88:91], v[32:35]
    ds_read_b64_tr_b16 v[70:71], v130 offset:24928
    v_mfma_f32_16x16x32_bf16 v[32:35], v[72:75], v[84:87], v[32:35]
    ds_read_b64_tr_b16 v[72:73], v130 offset:21632
    s_waitcnt lgkmcnt(13)
    v_mfma_f32_16x16x32_bf16 v[44:47], v[76:79], v[88:91], v[40:43]
    ds_read_b64_tr_b16 v[74:75], v130 offset:24960
    v_mfma_f32_16x16x32_bf16 v[40:43], v[76:79], v[84:87], v[40:43]
    ds_read_b64_tr_b16 v[76:77], v130 offset:21664
    s_waitcnt lgkmcnt(13)
    v_mfma_f32_16x16x32_bf16 v[52:55], v[80:83], v[88:91], v[48:51]
    ds_read_b64_tr_b16 v[78:79], v130 offset:24992
    v_mfma_f32_16x16x32_bf16 v[48:51], v[80:83], v[84:87], v[48:51]
    ds_read_b64_tr_b16 v[80:81], v130 offset:21696
    s_waitcnt vmcnt(2)
    s_barrier
    s_add_u32 m0, s56, 86016
    v_lshl_add_u32 v104, v104, 6, v136
    buffer_load_dwordx4 v104, s[8:11], 0 offen lds
    s_add_u32 s54, s54, 53248
    s_cmp_lg_u32 s58, 0
    s_cbranch_scc1 L_np_17
    s_add_u32 m0, s57, 86016
    s_nop 0
    buffer_load_dwordx4 v129, s[12:15], s54 offen lds
L_np_17:
    s_add_u32 m0, s55, 86016
    s_nop 0
    buffer_load_dwordx4 v128, s[12:15], s54 offen lds
    s_waitcnt lgkmcnt(10)
    v_mfma_f32_16x16x32_bf16 v[4:7], v[56:59], v[96:99], v[4:7]
    ds_read_b64_tr_b16 v[82:83], v130 offset:25024
    v_mfma_f32_16x16x32_bf16 v[0:3], v[56:59], v[92:95], v[0:3]
    ds_read_b64_tr_b16 v[56:57], v130 offset:43008
    s_waitcnt lgkmcnt(11)
    v_mfma_f32_16x16x32_bf16 v[12:15], v[60:63], v[96:99], v[12:15]
    ds_read_b64_tr_b16 v[58:59], v130 offset:46336
    v_mfma_f32_16x16x32_bf16 v[8:11], v[60:63], v[92:95], v[8:11]
    ds_read_b64_tr_b16 v[60:61], v130 offset:43040
    ds_read_b128 v[84:87], v133 offset:43008
    ds_read_b128 v[88:91], v133 offset:44032
    s_waitcnt lgkmcnt(13)
    v_mfma_f32_16x16x32_bf16 v[20:23], v[64:67], v[96:99], v[20:23]
    ds_read_b64_tr_b16 v[62:63], v130 offset:46368
    v_mfma_f32_16x16x32_bf16 v[16:19], v[64:67], v[92:95], v[16:19]
    ds_read_b64_tr_b16 v[64:65], v130 offset:43072
    s_waitcnt lgkmcnt(13)
    v_mfma_f32_16x16x32_bf16 v[28:31], v[68:71], v[96:99], v[28:31]
    ds_read_b64_tr_b16 v[66:67], v130 offset:46400
    v_mfma_f32_16x16x32_bf16 v[24:27], v[68:71], v[92:95], v[24:27]
    ds_read_b64_tr_b16 v[68:69], v130 offset:43104
    s_waitcnt lgkmcnt(13)
    v_mfma_f32_16x16x32_bf16 v[36:39], v[72:75], v[96:99], v[36:39]
    ds_read_b64_tr_b16 v[70:71], v130 offset:46432
    v_mfma_f32_16x16x32_bf16 v[32:35], v[72:75], v[92:95], v[32:35]
    ds_read_b64_tr_b16 v[72:73], v130 offset:43136
    s_waitcnt lgkmcnt(13)
    v_mfma_f32_16x16x32_bf16 v[44:47], v[76:79], v[96:99], v[44:47]
    ds_read_b64_tr_b16 v[74:75], v130 offset:46464
    v_mfma_f32_16x16x32_bf16 v[40:43], v[76:79], v[92:95], v[40:43]
    ds_read_b64_tr_b16 v[76:77], v130 offset:43168
    s_waitcnt lgkmcnt(13)
    v_mfma_f32_16x16x32_bf16 v[52:55], v[80:83], v[96:99], v[52:55]
    ds_read_b64_tr_b16 v[78:79], v130 offset:46496
    v_mfma_f32_16x16x32_bf16 v[48:51], v[80:83], v[92:95], v[48:51]
    ds_read_b64_tr_b16 v[80:81], v130 offset:43200
    s_waitcnt vmcnt(2)
    s_barrier
    s_add_u32 m0, s56, 107520
    v_lshl_add_u32 v105, v105, 6, v136
    buffer_load_dwordx4 v105, s[8:11], 0 offen lds
    s_add_u32 s54, s54, 53248
    s_cmp_lg_u32 s58, 1
    s_cbranch_scc1 L_np_18
    s_add_u32 m0, s57, 107520
    s_nop 0
    buffer_load_dwordx4 v129, s[12:15], s54 offen lds
L_np_18:
    s_add_u32 m0, s55, 107520
    s_nop 0
    buffer_load_dwordx4 v128, s[12:15], s54 offen lds
    s_waitcnt lgkmcnt(10)
    v_mfma_f32_16x16x32_bf16 v[4:7], v[56:59], v[88:91], v[4:7]
    ds_read_b64_tr_b16 v[82:83], v130 offset:46528
    v_mfma_f32_16x16x32_bf16 v[0:3], v[56:59], v[84:87], v[0:3]
    ds_read_b64_tr_b16 v[56:57], v131 offset:0
    s_waitcnt lgkmcnt(11)
    v_mfma_f32_16x16x32_bf16 v[12:15], v[60:63], v[88:91], v[12:15]
    ds_read_b64_tr_b16 v[58:59], v131 offset:3328
    v_mfma_f32_16x16x32_bf16 v[8:11], v[60:63], v[84:87], v[8:11]
    ds_read_b64_tr_b16 v[60:61], v131 offset:32
    ds_read_b128 v[92:95], v134 offset:0
    ds_read_b128 v[96:99], v134 offset:1024
    s_waitcnt lgkmcnt(13)
    v_mfma_f32_16x16x32_bf16 v[20:23], v[64:67], v[88:91], v[20:23]
    ds_read_b64_tr_b16 v[62:63], v131 offset:3360
    v_mfma_f32_16x16x32_bf16 v[16:19], v[64:67], v[84:87], v[16:19]
    ds_read_b64_tr_b16 v[64:65], v131 offset:64
    s_waitcnt lgkmcnt(13)
    v_mfma_f32_16x16x32_bf16 v[28:31], v[68:71], v[88:91], v[28:31]
    ds_read_b64_tr_b16 v[66:67], v131 offset:3392
    v_mfma_f32_16x16x32_bf16 v[24:27], v[68:71], v[84:87], v[24:27]
    ds_read_b64_tr_b16 v[68:69], v131 offset:96
    s_waitcnt lgkmcnt(13)
    v_mfma_f32_16x16x32_bf16 v[36:39], v[72:75], v[88:91], v[36:39]
    ds_read_b64_tr_b16 v[70:71], v131 offset:3424
    v_mfma_f32_16x16x32_bf16 v[32:35], v[72:75], v[84:87], v[32:35]
    ds_read_b64_tr_b16 v[72:73], v131 offset:128
    s_waitcnt lgkmcnt(13)
    v_mfma_f32_16x16x32_bf16 v[44:47], v[76:79], v[88:91], v[44:47]
    ds_read_b64_tr_b16 v[74:75], v131 offset:3456
    v_mfma_f32_16x16x32_bf16 v[40:43], v[76:79], v[84:87], v[40:43]
    ds_read_b64_tr_b16 v[76:77], v131 offset:160
    s_waitcnt lgkmcnt(13)
    v_mfma_f32_16x16x32_bf16 v[52:55], v[80:83], v[88:91], v[52:55]
    ds_read_b64_tr_b16 v[78:79], v131 offset:3488
    v_mfma_f32_16x16x32_bf16 v[48:51], v[80:83], v[84:87], v[48:51]
    ds_read_b64_tr_b16 v[80:81], v131 offset:192
    s_waitcnt vmcnt(2)
    s_barrier
    s_add_u32 m0, s56, 129024
    v_lshl_add_u32 v106, v106, 6, v136
    buffer_load_dwordx4 v106, s[8:11], 0 offen lds
    s_add_u32 s54, s54, 53248
    s_cmp_lg_u32 s58, 2
    s_cbranch_scc1 L_np_19
    s_add_u32 m0, s57, 129024
    s_nop 0
    buffer_load_dwordx4 v129, s[12:15], s54 offen lds
L_np_19:
    s_add_u32 m0, s55, 129024
    s_nop 0
    buffer_load_dwordx4 v128, s[12:15], s54 offen lds
    s_waitcnt lgkmcnt(10)
    v_mfma_f32_16x16x32_bf16 v[4:7], v[56:59], v[96:99], v[4:7]
    ds_read_b64_tr_b16 v[82:83], v131 offset:3520
    v_mfma_f32_16x16x32_bf16 v[0:3], v[56:59], v[92:95], v[0:3]
    ds_read_b64_tr_b16 v[56:57], v131 offset:21504
    s_waitcnt lgkmcnt(11)
    v_mfma_f32_16x16x32_bf16 v[12:15], v[60:63], v[96:99], v[12:15]
    ds_read_b64_tr_b16 v[58:59], v131 offset:24832
    v_mfma_f32_16x16x32_bf16 v[8:11], v[60:63], v[92:95], v[8:11]
    ds_read_b64_tr_b16 v[60:61], v131 offset:21536
    ds_read_b128 v[84:87], v134 offset:21504
    ds_read_b128 v[88:91], v134 offset:22528
    s_waitcnt lgkmcnt(13)
    v_mfma_f32_16x16x32_bf16 v[20:23], v[64:67], v[96:99], v[20:23]
    ds_read_b64_tr_b16 v[62:63], v131 offset:24864
    v_mfma_f32_16x16x32_bf16 v[16:19], v[64:67], v[92:95], v[16:19]
    ds_read_b64_tr_b16 v[64:65], v131 offset:21568
    s_waitcnt lgkmcnt(13)
    v_mfma_f32_16x16x32_bf16 v[28:31], v[68:71], v[96:99], v[28:31]
    ds_read_b64_tr_b16 v[66:67], v131 offset:24896
    v_mfma_f32_16x16x32_bf16 v[24:27], v[68:71], v[92:95], v[24:27]
    ds_read_b64_tr_b16 v[68:69], v131 offset:21600
    s_waitcnt lgkmcnt(13)
    v_mfma_f32_16x16x32_bf16 v[36:39], v[72:75], v[96:99], v[36:39]
    ds_read_b64_tr_b16 v[70:71], v131 offset:24928
    v_mfma_f32_16x16x32_bf16 v[32:35], v[72:75], v[92:95], v[32:35]
    ds_read_b64_tr_b16 v[72:73], v131 offset:21632
    s_waitcnt lgkmcnt(13)
    v_mfma_f32_16x16x32_bf16 v[44:47], v[76:79], v[96:99], v[44:47]
    ds_read_b64_tr_b16 v[74:75], v131 offset:24960
    v_mfma_f32_16x16x32_bf16 v[40:43], v[76:79], v[92:95], v[40:43]
    ds_read_b64_tr_b16 v[76:77], v131 offset:21664
    s_waitcnt lgkmcnt(13)
    v_mfma_f32_16x16x32_bf16 v[52:55], v[80:83], v[96:99], v[52:55]
    ds_read_b64_tr_b16 v[78:79], v131 offset:24992
    v_mfma_f32_16x16x32_bf16 v[48:51], v[80:83], v[92:95], v[48:51]
    ds_read_b64_tr_b16 v[80:81], v131 offset:21696
    s_waitcnt vmcnt(2)
    s_barrier
    s_add_u32 m0, s56, 0
    v_lshl_add_u32 v107, v107, 6, v136
    buffer_load_dwordx4 v107, s[8:11], 0 offen lds
    s_add_u32 s54, s54, 53248
    s_cmp_lg_u32 s58, 3
    s_cbranch_scc1 L_np_20
    s_add_u32 m0, s57, 0
    s_nop 0
    buffer_load_dwordx4 v129, s[12:15], s54 offen lds
L_np_20:
    s_add_u32 m0, s55, 0
    s_nop 0
    buffer_load_dwordx4 v128, s[12:15], s54 offen lds
    s_add_u32 m0, s56, 21504
    v_lshl_add_u32 v108, v108, 6, v136
    buffer_load_dwordx4 v108, s[8:11], 0 offen lds
    s_add_u32 s54, s54, 53248
    s_cmp_lg_u32 s58, 0
    s_cbranch_scc1 L_np_21
    s_add_u32 m0, s57, 21504
    s_nop 0
    buffer_load_dwordx4 v129, s[12:15], s54 offen lds
L_np_21:
    s_add_u32 m0, s55, 21504
    s_nop 0
    buffer_load_dwordx4 v128, s[12:15], s54 offen lds
    s_waitcnt lgkmcnt(10)
    v_mfma_f32_16x16x32_bf16 v[4:7], v[56:59], v[88:91], v[4:7]
    ds_read_b64_tr_b16 v[82:83], v131 offset:25024
    v_mfma_f32_16x16x32_bf16 v[0:3], v[56:59], v[84:87], v[0:3]
    ds_read_b64_tr_b16 v[56:57], v131 offset:43008
    s_waitcnt lgkmcnt(11)
    v_mfma_f32_16x16x32_bf16 v[12:15], v[60:63], v[88:91], v[12:15]
    ds_read_b64_tr_b16 v[58:59], v131 offset:46336
    v_mfma_f32_16x16x32_bf16 v[8:11], v[60:63], v[84:87], v[8:11]
    ds_read_b64_tr_b16 v[60:61], v131 offset:43040
    ds_read_b128 v[92:95], v134 offset:43008
    ds_read_b128 v[96:99], v134 offset:44032
    s_waitcnt lgkmcnt(13)
    v_mfma_f32_16x16x32_bf16 v[20:23], v[64:67], v[88:91], v[20:23]
    ds_read_b64_tr_b16 v[62:63], v131 offset:46368
    v_mfma_f32_16x16x32_bf16 v[16:19], v[64:67], v[84:87], v[16:19]
    ds_read_b64_tr_b16 v[64:65], v131 offset:43072
    s_waitcnt lgkmcnt(13)
    v_mfma_f32_16x16x32_bf16 v[28:31], v[68:71], v[88:91], v[28:31]
    ds_read_b64_tr_b16 v[66:67], v131 offset:46400
    v_mfma_f32_16x16x32_bf16 v[24:27], v[68:71], v[84:87], v[24:27]
    ds_read_b64_tr_b16 v[68:69], v131 offset:43104
    s_waitcnt lgkmcnt(13)
    v_mfma_f32_16x16x32_bf16 v[36:39], v[72:75], v[88:91], v[36:39]
    ds_read_b64_tr_b16 v[70:71], v131 offset:46432
    v_mfma_f32_16x16x32_bf16 v[32:35], v[72:75], v[84:87], v[32:35]
    ds_read_b64_tr_b16 v[72:73], v131 offset:43136
    s_waitcnt lgkmcnt(13)
    v_mfma_f32_16x16x32_bf16 v[44:47], v[76:79], v[88:91], v[44:47]
    ds_read_b64_tr_b16 v[74:75], v131 offset:46464
    v_mfma_f32_16x16x32_bf16 v[40:43], v[76:79], v[84:87], v[40:43]
    ds_read_b64_tr_b16 v[76:77], v131 offset:43168
    s_waitcnt lgkmcnt(13)
    v_mfma_f32_16x16x32_bf16 v[52:55], v[80:83], v[88:91], v[52:55]
    ds_read_b64_tr_b16 v[78:79], v131 offset:46496
    v_mfma_f32_16x16x32_bf16 v[48:51], v[80:83], v[84:87], v[48:51]
    ds_read_b64_tr_b16 v[80:81], v131 offset:43200
    s_waitcnt vmcnt(4)
    s_barrier
    s_add_u32 m0, s56, 43008
    v_lshl_add_u32 v109, v109, 6, v136
    buffer_load_dwordx4 v109, s[8:11], 0 offen lds
    s_add_u32 s54, s54, 53248
    s_cmp_lg_u32 s58, 1
    s_cbranch_scc1 L_np_22
    s_add_u32 m0, s57, 43008
    s_nop 0
    buffer_load_dwordx4 v129, s[12:15], s54 offen lds
L_np_22:
    s_add_u32 m0, s55, 43008
    s_nop 0
    buffer_load_dwordx4 v128, s[12:15], s54 offen lds
    s_add_u32 m0, s56, 64512
    v_lshl_add_u32 v110, v110, 6, v136
    buffer_load_dwordx4 v110, s[8:11], 0 offen lds
    s_add_u32 s54, s54, 53248
    s_cmp_lg_u32 s58, 2
    s_cbranch_scc1 L_np_23
    s_add_u32 m0, s57, 64512
    s_nop 0
    buffer_load_dwordx4 v129, s[12:15], s54 offen lds
L_np_23:
    s_add_u32 m0, s55, 64512
    s_nop 0
    buffer_load_dwordx4 v128, s[12:15], s54 offen lds
    s_waitcnt lgkmcnt(10)
    v_mfma_f32_16x16x32_bf16 v[4:7], v[56:59], v[96:99], v[4:7]
    ds_read_b64_tr_b16 v[82:83], v131 offset:46528
    v_mfma_f32_16x16x32_bf16 v[0:3], v[56:59], v[92:95], v[0:3]
    ds_read_b64_tr_b16 v[56:57], v132 offset:0
    s_waitcnt lgkmcnt(11)
    v_mfma_f32_16x16x32_bf16 v[12:15], v[60:63], v[96:99], v[12:15]
    ds_read_b64_tr_b16 v[58:59], v132 offset:3328
    v_mfma_f32_16x16x32_bf16 v[8:11], v[60:63], v[92:95], v[8:11]
    ds_read_b64_tr_b16 v[60:61], v132 offset:32
    ds_read_b128 v[84:87], v135 offset:0
    ds_read_b128 v[88:91], v135 offset:1024
    s_waitcnt lgkmcnt(13)
    v_mfma_f32_16x16x32_bf16 v[20:23], v[64:67], v[96:99], v[20:23]
    ds_read_b64_tr_b16 v[62:63], v132 offset:3360
    v_mfma_f32_16x16x32_bf16 v[16:19], v[64:67], v[92:95], v[16:19]
    ds_read_b64_tr_b16 v[64:65], v132 offset:64
    s_waitcnt lgkmcnt(13)
    v_mfma_f32_16x16x32_bf16 v[28:31], v[68:71], v[96:99], v[28:31]
    ds_read_b64_tr_b16 v[66:67], v132 offset:3392
    v_mfma_f32_16x16x32_bf16 v[24:27], v[68:71], v[92:95], v[24:27]
    ds_read_b64_tr_b16 v[68:69], v132 offset:96
    s_waitcnt lgkmcnt(13)
    v_mfma_f32_16x16x32_bf16 v[36:39], v[72:75], v[96:99], v[36:39]
    ds_read_b64_tr_b16 v[70:71], v132 offset:3424
    v_mfma_f32_16x16x32_bf16 v[32:35], v[72:75], v[92:95], v[32:35]
    ds_read_b64_tr_b16 v[72:73], v132 offset:128
    s_waitcnt lgkmcnt(13)
    v_mfma_f32_16x16x32_bf16 v[44:47], v[76:79], v[96:99], v[44:47]
    ds_read_b64_tr_b16 v[74:75], v132 offset:3456
    v_mfma_f32_16x16x32_bf16 v[40:43], v[76:79], v[92:95], v[40:43]
    ds_read_b64_tr_b16 v[76:77], v132 offset:160
    s_waitcnt lgkmcnt(13)
    v_mfma_f32_16x16x32_bf16 v[52:55], v[80:83], v[96:99], v[52:55]
    ds_read_b64_tr_b16 v[78:79], v132 offset:3488
    v_mfma_f32_16x16x32_bf16 v[48:51], v[80:83], v[92:95], v[48:51]
    ds_read_b64_tr_b16 v[80:81], v132 offset:192
    s_waitcnt vmcnt(6)
    s_barrier
    s_waitcnt lgkmcnt(10)
    v_mfma_f32_16x16x32_bf16 v[4:7], v[56:59], v[88:91], v[4:7]
    ds_read_b64_tr_b16 v[82:83], v132 offset:3520
    v_mfma_f32_16x16x32_bf16 v[0:3], v[56:59], v[84:87], v[0:3]
    ds_read_b64_tr_b16 v[56:57], v130 offset:0
    s_waitcnt lgkmcnt(11)
    v_mfma_f32_16x16x32_bf16 v[12:15], v[60:63], v[88:91], v[12:15]
    ds_read_b64_tr_b16 v[58:59], v130 offset:3328
    v_mfma_f32_16x16x32_bf16 v[8:11], v[60:63], v[84:87], v[8:11]
    ds_read_b64_tr_b16 v[60:61], v130 offset:32
    ds_read_b128 v[92:95], v133 offset:0
    ds_read_b128 v[96:99], v133 offset:1024
    s_waitcnt lgkmcnt(13)
    v_mfma_f32_16x16x32_bf16 v[20:23], v[64:67], v[88:91], v[20:23]
    ds_read_b64_tr_b16 v[62:63], v130 offset:3360
    v_mfma_f32_16x16x32_bf16 v[16:19], v[64:67], v[84:87], v[16:19]
    ds_read_b64_tr_b16 v[64:65], v130 offset:64
    s_waitcnt lgkmcnt(13)
    v_mfma_f32_16x16x32_bf16 v[28:31], v[68:71], v[88:91], v[28:31]
    ds_read_b64_tr_b16 v[66:67], v130 offset:3392
    v_mfma_f32_16x16x32_bf16 v[24:27], v[68:71], v[84:87], v[24:27]
    ds_read_b64_tr_b16 v[68:69], v130 offset:96
    s_waitcnt lgkmcnt(13)
    v_mfma_f32_16x16x32_bf16 v[36:39], v[72:75], v[88:91], v[36:39]
    ds_read_b64_tr_b16 v[70:71], v130 offset:3424
    v_mfma_f32_16x16x32_bf16 v[32:35], v[72:75], v[84:87], v[32:35]
    ds_read_b64_tr_b16 v[72:73], v130 offset:128
    s_waitcnt lgkmcnt(13)
    v_mfma_f32_16x16x32_bf16 v[44:47], v[76:79], v[88:91], v[44:47]
    ds_read_b64_tr_b16 v[74:75], v130 offset:3456
    v_mfma_f32_16x16x32_bf16 v[40:43], v[76:79], v[84:87], v[40:43]
    ds_read_b64_tr_b16 v[76:77], v130 offset:160
    s_waitcnt lgkmcnt(13)
    v_mfma_f32_16x16x32_bf16 v[52:55], v[80:83], v[88:91], v[52:55]
    ds_read_b64_tr_b16 v[78:79], v130 offset:3488
    v_mfma_f32_16x16x32_bf16 v[48:51], v[80:83], v[84:87], v[48:51]
    ds_read_b64_tr_b16 v[80:81], v130 offset:192
    s_add_u32 m0, s56, 86016
    v_lshl_add_u32 v111, v111, 6, v136
    buffer_load_dwordx4 v111, s[8:11], 0 offen lds
    s_add_u32 s54, s54, 53248
    s_cmp_lg_u32 s58, 3
    s_cbranch_scc1 L_np_24
    s_add_u32 m0, s57, 86016
    s_nop 0
    buffer_load_dwordx4 v129, s[12:15], s54 offen lds
L_np_24:
    s_add_u32 m0, s55, 86016
    s_nop 0
    buffer_load_dwordx4 v128, s[12:15], s54 offen lds
    s_add_u32 m0, s56, 107520
    v_lshl_add_u32 v112, v112, 6, v136
    buffer_load_dwordx4 v112, s[8:11], 0 offen lds
    s_add_u32 s54, s54, 53248
    s_cmp_lg_u32 s58, 0
    s_cbranch_scc1 L_np_25
    s_add_u32 m0, s57, 107520
    s_nop 0
    buffer_load_dwordx4 v129, s[12:15], s54 offen lds
L_np_25:
    s_add_u32 m0, s55, 107520
    s_nop 0
    buffer_load_dwordx4 v128, s[12:15], s54 offen lds
    s_waitcnt vmcnt(8)
    s_barrier
    s_waitcnt lgkmcnt(10)
    v_mfma_f32_16x16x32_bf16 v[4:7], v[56:59], v[96:99], v[4:7]
    ds_read_b64_tr_b16 v[82:83], v130 offset:3520
    v_mfma_f32_16x16x32_bf16 v[0:3], v[56:59], v[92:95], v[0:3]
    ds_read_b64_tr_b16 v[56:57], v130 offset:21504
    s_waitcnt lgkmcnt(11)
    v_mfma_f32_16x16x32_bf16 v[12:15], v[60:63], v[96:99], v[12:15]
    ds_read_b64_tr_b16 v[58:59], v130 offset:24832
    v_mfma_f32_16x16x32_bf16 v[8:11], v[60:63], v[92:95], v[8:11]
    ds_read_b64_tr_b16 v[60:61], v130 offset:21536
    ds_read_b128 v[84:87], v133 offset:21504
    ds_read_b128 v[88:91], v133 offset:22528
    s_waitcnt lgkmcnt(13)
    v_mfma_f32_16x16x32_bf16 v[20:23], v[64:67], v[96:99], v[20:23]
    ds_read_b64_tr_b16 v[62:63], v130 offset:24864
    v_mfma_f32_16x16x32_bf16 v[16:19], v[64:67], v[92:95], v[16:19]
    ds_read_b64_tr_b16 v[64:65], v130 offset:21568
    s_waitcnt lgkmcnt(13)
    v_mfma_f32_16x16x32_bf16 v[28:31], v[68:71], v[96:99], v[28:31]
    ds_read_b64_tr_b16 v[66:67], v130 offset:24896
    v_mfma_f32_16x16x32_bf16 v[24:27], v[68:71], v[92:95], v[24:27]
    ds_read_b64_tr_b16 v[68:69], v130 offset:21600
    s_waitcnt lgkmcnt(13)
    v_mfma_f32_16x16x32_bf16 v[36:39], v[72:75], v[96:99], v[36:39]
    ds_read_b64_tr_b16 v[70:71], v130 offset:24928
    v_mfma_f32_16x16x32_bf16 v[32:35], v[72:75], v[92:95], v[32:35]
    ds_read_b64_tr_b16 v[72:73], v130 offset:21632
    s_waitcnt lgkmcnt(13)
    v_mfma_f32_16x16x32_bf16 v[44:47], v[76:79], v[96:99], v[44:47]
    ds_read_b64_tr_b16 v[74:75], v130 offset:24960
    v_mfma_f32_16x16x32_bf16 v[40:43], v[76:79], v[92:95], v[40:43]
    ds_read_b64_tr_b16 v[76:77], v130 offset:21664
    s_waitcnt lgkmcnt(13)
    v_mfma_f32_16x16x32_bf16 v[52:55], v[80:83], v[96:99], v[52:55]
    ds_read_b64_tr_b16 v[78:79], v130 offset:24992
    v_mfma_f32_16x16x32_bf16 v[48:51], v[80:83], v[92:95], v[48:51]
    ds_read_b64_tr_b16 v[80:81], v130 offset:21696
    s_add_u32 m0, s56, 129024
    v_lshl_add_u32 v113, v113, 6, v136
    buffer_load_dwordx4 v113, s[8:11], 0 offen lds
    s_add_u32 s54, s54, 53248
    s_cmp_lg_u32 s58, 1
    s_cbranch_scc1 L_np_26
    s_add_u32 m0, s57, 129024
    s_nop 0
    buffer_load_dwordx4 v129, s[12:15], s54 offen lds
L_np_26:
    s_add_u32 m0, s55, 129024
    s_nop 0
    buffer_load_dwordx4 v128, s[12:15], s54 offen lds
    s_waitcnt vmcnt(8)
    s_barrier
    s_waitcnt lgkmcnt(10)
    v_mfma_f32_16x16x32_bf16 v[4:7], v[56:59], v[88:91], v[4:7]
    ds_read_b64_tr_b16 v[82:83], v130 offset:25024
    v_mfma_f32_16x16x32_bf16 v[0:3], v[56:59], v[84:87], v[0:3]
    ds_read_b64_tr_b16 v[56:57], v130 offset:43008
    s_waitcnt lgkmcnt(11)
    v_mfma_f32_16x16x32_bf16 v[12:15], v[60:63], v[88:91], v[12:15]
    ds_read_b64_tr_b16 v[58:59], v130 offset:46336
    v_mfma_f32_16x16x32_bf16 v[8:11], v[60:63], v[84:87], v[8:11]
    ds_read_b64_tr_b16 v[60:61], v130 offset:43040
    ds_read_b128 v[92:95], v133 offset:43008
    ds_read_b128 v[96:99], v133 offset:44032
    s_waitcnt lgkmcnt(13)
    v_mfma_f32_16x16x32_bf16 v[20:23], v[64:67], v[88:91], v[20:23]
    ds_read_b64_tr_b16 v[62:63], v130 offset:46368
    v_mfma_f32_16x16x32_bf16 v[16:19], v[64:67], v[84:87], v[16:19]
    ds_read_b64_tr_b16 v[64:65], v130 offset:43072
    s_waitcnt lgkmcnt(13)
    v_mfma_f32_16x16x32_bf16 v[28:31], v[68:71], v[88:91], v[28:31]
    ds_read_b64_tr_b16 v[66:67], v130 offset:46400
    v_mfma_f32_16x16x32_bf16 v[24:27], v[68:71], v[84:87], v[24:27]
    ds_read_b64_tr_b16 v[68:69], v130 offset:43104
    s_waitcnt lgkmcnt(13)
    v_mfma_f32_16x16x32_bf16 v[36:39], v[72:75], v[88:91], v[36:39]
    ds_read_b64_tr_b16 v[70:71], v130 offset:46432
    v_mfma_f32_16x16x32_bf16 v[32:35], v[72:75], v[84:87], v[32:35]
    ds_read_b64_tr_b16 v[72:73], v130 offset:43136
    s_waitcnt lgkmcnt(13)
    v_mfma_f32_16x16x32_bf16 v[44:47], v[76:79], v[88:91], v[44:47]
    ds_read_b64_tr_b16 v[74:75], v130 offset:46464
    v_mfma_f32_16x16x32_bf16 v[40:43], v[76:79], v[84:87], v[40:43]
    ds_read_b64_tr_b16 v[76:77], v130 offset:43168
    s_waitcnt lgkmcnt(13)
    v_mfma_f32_16x16x32_bf16 v[52:55], v[80:83], v[88:91], v[52:55]
    ds_read_b64_tr_b16 v[78:79], v130 offset:46496
    v_mfma_f32_16x16x32_bf16 v[48:51], v[80:83], v[84:87], v[48:51]
    ds_read_b64_tr_b16 v[80:81], v130 offset:43200
    s_add_u32 m0, s56, 0
    v_lshl_add_u32 v114, v114, 6, v136
    buffer_load_dwordx4 v114, s[8:11], 0 offen lds
    s_add_u32 s54, s54, 53248
    s_cmp_lg_u32 s58, 2
    s_cbranch_scc1 L_np_27
    s_add_u32 m0, s57, 0
    s_nop 0
    buffer_load_dwordx4 v129, s[12:15], s54 offen lds
L_np_27:
    s_add_u32 m0, s55, 0
    s_nop 0
    buffer_load_dwordx4 v128, s[12:15], s54 offen lds
    s_waitcnt vmcnt(8)
    s_barrier
    s_waitcnt lgkmcnt(10)
    v_mfma_f32_16x16x32_bf16 v[4:7], v[56:59], v[96:99], v[4:7]
    ds_read_b64_tr_b16 v[82:83], v130 offset:46528
    v_mfma_f32_16x16x32_bf16 v[0:3], v[56:59], v[92:95], v[0:3]
    ds_read_b64_tr_b16 v[56:57], v131 offset:0
    s_waitcnt lgkmcnt(11)
    v_mfma_f32_16x16x32_bf16 v[12:15], v[60:63], v[96:99], v[12:15]
    ds_read_b64_tr_b16 v[58:59], v131 offset:3328
    v_mfma_f32_16x16x32_bf16 v[8:11], v[60:63], v[92:95], v[8:11]
    ds_read_b64_tr_b16 v[60:61], v131 offset:32
    ds_read_b128 v[84:87], v134 offset:0
    ds_read_b128 v[88:91], v134 offset:1024
    s_waitcnt lgkmcnt(13)
    v_mfma_f32_16x16x32_bf16 v[20:23], v[64:67], v[96:99], v[20:23]
    ds_read_b64_tr_b16 v[62:63], v131 offset:3360
    v_mfma_f32_16x16x32_bf16 v[16:19], v[64:67], v[92:95], v[16:19]
    ds_read_b64_tr_b16 v[64:65], v131 offset:64
    s_waitcnt lgkmcnt(13)
    v_mfma_f32_16x16x32_bf16 v[28:31], v[68:71], v[96:99], v[28:31]
    ds_read_b64_tr_b16 v[66:67], v131 offset:3392
    v_mfma_f32_16x16x32_bf16 v[24:27], v[68:71], v[92:95], v[24:27]
    ds_read_b64_tr_b16 v[68:69], v131 offset:96
    s_waitcnt lgkmcnt(13)
    v_mfma_f32_16x16x32_bf16 v[36:39], v[72:75], v[96:99], v[36:39]
    ds_read_b64_tr_b16 v[70:71], v131 offset:3424
    v_mfma_f32_16x16x32_bf16 v[32:35], v[72:75], v[92:95], v[32:35]
    ds_read_b64_tr_b16 v[72:73], v131 offset:128
    s_waitcnt lgkmcnt(13)
    v_mfma_f32_16x16x32_bf16 v[44:47], v[76:79], v[96:99], v[44:47]
    ds_read_b64_tr_b16 v[74:75], v131 offset:3456
    v_mfma_f32_16x16x32_bf16 v[40:43], v[76:79], v[92:95], v[40:43]
    ds_read_b64_tr_b16 v[76:77], v131 offset:160
    s_waitcnt lgkmcnt(13)
    v_mfma_f32_16x16x32_bf16 v[52:55], v[80:83], v[96:99], v[52:55]
    ds_read_b64_tr_b16 v[78:79], v131 offset:3488
    v_mfma_f32_16x16x32_bf16 v[48:51], v[80:83], v[92:95], v[48:51]
    ds_read_b64_tr_b16 v[80:81], v131 offset:192
    s_add_u32 m0, s56, 21504
    v_lshl_add_u32 v115, v115, 6, v136
    buffer_load_dwordx4 v115, s[8:11], 0 offen lds
    s_add_u32 s54, s54, 53248
    s_cmp_lg_u32 s58, 3
    s_cbranch_scc1 L_np_28
    s_add_u32 m0, s57, 21504
    s_nop 0
    buffer_load_dwordx4 v129, s[12:15], s54 offen lds
L_np_28:
    s_add_u32 m0, s55, 21504
    s_nop 0
    buffer_load_dwordx4 v128, s[12:15], s54 offen lds
    s_waitcnt vmcnt(8)
    s_barrier
    s_waitcnt lgkmcnt(10)
    v_mfma_f32_16x16x32_bf16 v[4:7], v[56:59], v[88:91], v[4:7]
    ds_read_b64_tr_b16 v[82:83], v131 offset:3520
    v_mfma_f32_16x16x32_bf16 v[0:3], v[56:59], v[84:87], v[0:3]
    ds_read_b64_tr_b16 v[56:57], v131 offset:21504
    s_waitcnt lgkmcnt(11)
    v_mfma_f32_16x16x32_bf16 v[12:15], v[60:63], v[88:91], v[12:15]
    ds_read_b64_tr_b16 v[58:59], v131 offset:24832
    v_mfma_f32_16x16x32_bf16 v[8:11], v[60:63], v[84:87], v[8:11]
    ds_read_b64_tr_b16 v[60:61], v131 offset:21536
    ds_read_b128 v[92:95], v134 offset:21504
    ds_read_b128 v[96:99], v134 offset:22528
    s_waitcnt lgkmcnt(13)
    v_mfma_f32_16x16x32_bf16 v[20:23], v[64:67], v[88:91], v[20:23]
    ds_read_b64_tr_b16 v[62:63], v131 offset:24864
    v_mfma_f32_16x16x32_bf16 v[16:19], v[64:67], v[84:87], v[16:19]
    ds_read_b64_tr_b16 v[64:65], v131 offset:21568
    s_waitcnt lgkmcnt(13)
    v_mfma_f32_16x16x32_bf16 v[28:31], v[68:71], v[88:91], v[28:31]
    ds_read_b64_tr_b16 v[66:67], v131 offset:24896
    v_mfma_f32_16x16x32_bf16 v[24:27], v[68:71], v[84:87], v[24:27]
    ds_read_b64_tr_b16 v[68:69], v131 offset:21600
    s_waitcnt lgkmcnt(13)
    v_mfma_f32_16x16x32_bf16 v[36:39], v[72:75], v[88:91], v[36:39]
    ds_read_b64_tr_b16 v[70:71], v131 offset:24928
    v_mfma_f32_16x16x32_bf16 v[32:35], v[72:75], v[84:87], v[32:35]
    ds_read_b64_tr_b16 v[72:73], v131 offset:21632
    s_waitcnt lgkmcnt(13)
    v_mfma_f32_16x16x32_bf16 v[44:47], v[76:79], v[88:91], v[44:47]
    ds_read_b64_tr_b16 v[74:75], v131 offset:24960
    v_mfma_f32_16x16x32_bf16 v[40:43], v[76:79], v[84:87], v[40:43]
    ds_read_b64_tr_b16 v[76:77], v131 offset:21664
    s_waitcnt lgkmcnt(13)
    v_mfma_f32_16x16x32_bf16 v[52:55], v[80:83], v[88:91], v[52:55]
    ds_read_b64_tr_b16 v[78:79], v131 offset:24992
    v_mfma_f32_16x16x32_bf16 v[48:51], v[80:83], v[84:87], v[48:51]
    ds_read_b64_tr_b16 v[80:81], v131 offset:21696
    s_add_u32 m0, s56, 43008
    v_lshl_add_u32 v116, v116, 6, v136
    buffer_load_dwordx4 v116, s[8:11], 0 offen lds
    s_add_u32 s54, s54, 53248
    s_cmp_lg_u32 s58, 0
    s_cbranch_scc1 L_np_29
    s_add_u32 m0, s57, 43008
    s_nop 0
    buffer_load_dwordx4 v129, s[12:15], s54 offen lds
L_np_29:
    s_add_u32 m0, s55, 43008
    s_nop 0
    buffer_load_dwordx4 v128, s[12:15], s54 offen lds
    s_waitcnt vmcnt(8)
    s_barrier
    s_waitcnt lgkmcnt(10)
    v_mfma_f32_16x16x32_bf16 v[4:7], v[56:59], v[96:99], v[4:7]
    ds_read_b64_tr_b16 v[82:83], v131 offset:25024
    v_mfma_f32_16x16x32_bf16 v[0:3], v[56:59], v[92:95], v[0:3]
    ds_read_b64_tr_b16 v[56:57], v131 offset:43008
    s_waitcnt lgkmcnt(11)
    v_mfma_f32_16x16x32_bf16 v[12:15], v[60:63], v[96:99], v[12:15]
    ds_read_b64_tr_b16 v[58:59], v131 offset:46336
    v_mfma_f32_16x16x32_bf16 v[8:11], v[60:63], v[92:95], v[8:11]
    ds_read_b64_tr_b16 v[60:61], v131 offset:43040
    ds_read_b128 v[84:87], v134 offset:43008
    ds_read_b128 v[88:91], v134 offset:44032
    s_waitcnt lgkmcnt(13)
    v_mfma_f32_16x16x32_bf16 v[20:23], v[64:67], v[96:99], v[20:23]
    ds_read_b64_tr_b16 v[62:63], v131 offset:46368
    v_mfma_f32_16x16x32_bf16 v[16:19], v[64:67], v[92:95], v[16:19]
    ds_read_b64_tr_b16 v[64:65], v131 offset:43072
    s_waitcnt lgkmcnt(13)
    v_mfma_f32_16x16x32_bf16 v[28:31], v[68:71], v[96:99], v[28:31]
    ds_read_b64_tr_b16 v[66:67], v131 offset:46400
    v_mfma_f32_16x16x32_bf16 v[24:27], v[68:71], v[92:95], v[24:27]
    ds_read_b64_tr_b16 v[68:69], v131 offset:43104
    s_waitcnt lgkmcnt(13)
    v_mfma_f32_16x16x32_bf16 v[36:39], v[72:75], v[96:99], v[36:39]
    ds_read_b64_tr_b16 v[70:71], v131 offset:46432
    v_mfma_f32_16x16x32_bf16 v[32:35], v[72:75], v[92:95], v[32:35]
    ds_read_b64_tr_b16 v[72:73], v131 offset:43136
    s_waitcnt lgkmcnt(13)
    v_mfma_f32_16x16x32_bf16 v[44:47], v[76:79], v[96:99], v[44:47]
    ds_read_b64_tr_b16 v[74:75], v131 offset:46464
    v_mfma_f32_16x16x32_bf16 v[40:43], v[76:79], v[92:95], v[40:43]
    ds_read_b64_tr_b16 v[76:77], v131 offset:43168
    s_waitcnt lgkmcnt(13)
    v_mfma_f32_16x16x32_bf16 v[52:55], v[80:83], v[96:99], v[52:55]
    ds_read_b64_tr_b16 v[78:79], v131 offset:46496
    v_mfma_f32_16x16x32_bf16 v[48:51], v[80:83], v[92:95], v[48:51]
    ds_read_b64_tr_b16 v[80:81], v131 offset:43200
    s_add_u32 m0, s56, 64512
    v_lshl_add_u32 v117, v117, 6, v136
    buffer_load_dwordx4 v117, s[8:11], 0 offen lds
    s_add_u32 s54, s54, 53248
    s_cmp_lg_u32 s58, 1
    s_cbranch_scc1 L_np_30
    s_add_u32 m0, s57, 64512
    s_nop 0
    buffer_load_dwordx4 v129, s[12:15], s54 offen lds
L_np_30:
    s_add_u32 m0, s55, 64512
    s_nop 0
    buffer_load_dwordx4 v128, s[12:15], s54 offen lds
    s_waitcnt vmcnt(8)
    s_barrier
    s_waitcnt lgkmcnt(10)
    v_mfma_f32_16x16x32_bf16 v[4:7], v[56:59], v[88:91], v[4:7]
    ds_read_b64_tr_b16 v[82:83], v131 offset:46528
    v_mfma_f32_16x16x32_bf16 v[0:3], v[56:59], v[84:87], v[0:3]
    ds_read_b64_tr_b16 v[56:57], v132 offset:0
    s_waitcnt lgkmcnt(11)
    v_mfma_f32_16x16x32_bf16 v[12:15], v[60:63], v[88:91], v[12:15]
    ds_read_b64_tr_b16 v[58:59], v132 offset:3328
    v_mfma_f32_16x16x32_bf16 v[8:11], v[60:63], v[84:87], v[8:11]
    ds_read_b64_tr_b16 v[60:61], v132 offset:32
    ds_read_b128 v[92:95], v135 offset:0
    ds_read_b128 v[96:99], v135 offset:1024
    s_waitcnt lgkmcnt(13)
    v_mfma_f32_16x16x32_bf16 v[20:23], v[64:67], v[88:91], v[20:23]
    ds_read_b64_tr_b16 v[62:63], v132 offset:3360
    v_mfma_f32_16x16x32_bf16 v[16:19], v[64:67], v[84:87], v[16:19]
    ds_read_b64_tr_b16 v[64:65], v132 offset:64
    s_waitcnt lgkmcnt(13)
    v_mfma_f32_16x16x32_bf16 v[28:31], v[68:71], v[88:91], v[28:31]
    ds_read_b64_tr_b16 v[66:67], v132 offset:3392
    v_mfma_f32_16x16x32_bf16 v[24:27], v[68:71], v[84:87], v[24:27]
    ds_read_b64_tr_b16 v[68:69], v132 offset:96
    s_waitcnt lgkmcnt(13)
    v_mfma_f32_16x16x32_bf16 v[36:39], v[72:75], v[88:91], v[36:39]
    ds_read_b64_tr_b16 v[70:71], v132 offset:3424
    v_mfma_f32_16x16x32_bf16 v[32:35], v[72:75], v[84:87], v[32:35]
    ds_read_b64_tr_b16 v[72:73], v132 offset:128
    s_waitcnt lgkmcnt(13)
    v_mfma_f32_16x16x32_bf16 v[44:47], v[76:79], v[88:91], v[44:47]
    ds_read_b64_tr_b16 v[74:75], v132 offset:3456
    v_mfma_f32_16x16x32_bf16 v[40:43], v[76:79], v[84:87], v[40:43]
    ds_read_b64_tr_b16 v[76:77], v132 offset:160
    s_waitcnt lgkmcnt(13)
    v_mfma_f32_16x16x32_bf16 v[52:55], v[80:83], v[88:91], v[52:55]
    ds_read_b64_tr_b16 v[78:79], v132 offset:3488
    v_mfma_f32_16x16x32_bf16 v[48:51], v[80:83], v[84:87], v[48:51]
    ds_read_b64_tr_b16 v[80:81], v132 offset:192
    s_add_u32 m0, s56, 86016
    v_lshl_add_u32 v118, v118, 6, v136
    buffer_load_dwordx4 v118, s[8:11], 0 offen lds
    s_add_u32 s54, s54, 53248
    s_cmp_lg_u32 s58, 2
    s_cbranch_scc1 L_np_31
    s_add_u32 m0, s57, 86016
    s_nop 0
    buffer_load_dwordx4 v129, s[12:15], s54 offen lds
L_np_31:
    s_add_u32 m0, s55, 86016
    s_nop 0
    buffer_load_dwordx4 v128, s[12:15], s54 offen lds
    s_waitcnt vmcnt(8)
    s_barrier
    s_waitcnt lgkmcnt(10)
    v_mfma_f32_16x16x32_bf16 v[4:7], v[56:59], v[96:99], v[4:7]
    ds_read_b64_tr_b16 v[82:83], v132 offset:3520
    v_mfma_f32_16x16x32_bf16 v[0:3], v[56:59], v[92:95], v[0:3]
    ds_read_b64_tr_b16 v[56:57], v130 offset:0
    s_waitcnt lgkmcnt(11)
    v_mfma_f32_16x16x32_bf16 v[12:15], v[60:63], v[96:99], v[12:15]
    ds_read_b64_tr_b16 v[58:59], v130 offset:3328
    v_mfma_f32_16x16x32_bf16 v[8:11], v[60:63], v[92:95], v[8:11]
    ds_read_b64_tr_b16 v[60:61], v130 offset:32
    ds_read_b128 v[84:87], v133 offset:0
    ds_read_b128 v[88:91], v133 offset:1024
    s_waitcnt lgkmcnt(13)
    v_mfma_f32_16x16x32_bf16 v[20:23], v[64:67], v[96:99], v[20:23]
    ds_read_b64_tr_b16 v[62:63], v130 offset:3360
    v_mfma_f32_16x16x32_bf16 v[16:19], v[64:67], v[92:95], v[16:19]
    ds_read_b64_tr_b16 v[64:65], v130 offset:64
    s_waitcnt lgkmcnt(13)
    v_mfma_f32_16x16x32_bf16 v[28:31], v[68:71], v[96:99], v[28:31]
    ds_read_b64_tr_b16 v[66:67], v130 offset:3392
    v_mfma_f32_16x16x32_bf16 v[24:27], v[68:71], v[92:95], v[24:27]
    ds_read_b64_tr_b16 v[68:69], v130 offset:96
    s_waitcnt lgkmcnt(13)
    v_mfma_f32_16x16x32_bf16 v[36:39], v[72:75], v[96:99], v[36:39]
    ds_read_b64_tr_b16 v[70:71], v130 offset:3424
    v_mfma_f32_16x16x32_bf16 v[32:35], v[72:75], v[92:95], v[32:35]
    ds_read_b64_tr_b16 v[72:73], v130 offset:128
    s_waitcnt lgkmcnt(13)
    v_mfma_f32_16x16x32_bf16 v[44:47], v[76:79], v[96:99], v[44:47]
    ds_read_b64_tr_b16 v[74:75], v130 offset:3456
    v_mfma_f32_16x16x32_bf16 v[40:43], v[76:79], v[92:95], v[40:43]
    ds_read_b64_tr_b16 v[76:77], v130 offset:160
    s_waitcnt lgkmcnt(13)
    v_mfma_f32_16x16x32_bf16 v[52:55], v[80:83], v[96:99], v[52:55]
    ds_read_b64_tr_b16 v[78:79], v130 offset:3488
    v_mfma_f32_16x16x32_bf16 v[48:51], v[80:83], v[92:95], v[48:51]
    ds_read_b64_tr_b16 v[80:81], v130 offset:192
    s_add_u32 m0, s56, 107520
    v_lshl_add_u32 v119, v119, 6, v136
    buffer_load_dwordx4 v119, s[8:11], 0 offen lds
    s_add_u32 s54, s54, 53248
    s_cmp_lg_u32 s58, 3
    s_cbranch_scc1 L_np_32
    s_add_u32 m0, s57, 107520
    s_nop 0
    buffer_load_dwordx4 v129, s[12:15], s54 offen lds
L_np_32:
    s_add_u32 m0, s55, 107520
    s_nop 0
    buffer_load_dwordx4 v128, s[12:15], s54 offen lds
    s_waitcnt vmcnt(8)
    s_barrier
    s_waitcnt lgkmcnt(10)
    v_mfma_f32_16x16x32_bf16 v[4:7], v[56:59], v[88:91], v[4:7]
    ds_read_b64_tr_b16 v[82:83], v130 offset:3520
    v_mfma_f32_16x16x32_bf16 v[0:3], v[56:59], v[84:87], v[0:3]
    ds_read_b64_tr_b16 v[56:57], v130 offset:21504
    s_waitcnt lgkmcnt(11)
    v_mfma_f32_16x16x32_bf16 v[12:15], v[60:63], v[88:91], v[12:15]
    ds_read_b64_tr_b16 v[58:59], v130 offset:24832
    v_mfma_f32_16x16x32_bf16 v[8:11], v[60:63], v[84:87], v[8:11]
    ds_read_b64_tr_b16 v[60:61], v130 offset:21536
    ds_read_b128 v[92:95], v133 offset:21504
    ds_read_b128 v[96:99], v133 offset:22528
    s_waitcnt lgkmcnt(13)
    v_mfma_f32_16x16x32_bf16 v[20:23], v[64:67], v[88:91], v[20:23]
    ds_read_b64_tr_b16 v[62:63], v130 offset:24864
    v_mfma_f32_16x16x32_bf16 v[16:19], v[64:67], v[84:87], v[16:19]
    ds_read_b64_tr_b16 v[64:65], v130 offset:21568
    s_waitcnt lgkmcnt(13)
    v_mfma_f32_16x16x32_bf16 v[28:31], v[68:71], v[88:91], v[28:31]
    ds_read_b64_tr_b16 v[66:67], v130 offset:24896
    v_mfma_f32_16x16x32_bf16 v[24:27], v[68:71], v[84:87], v[24:27]
    ds_read_b64_tr_b16 v[68:69], v130 offset:21600
    s_waitcnt lgkmcnt(13)
    v_mfma_f32_16x16x32_bf16 v[36:39], v[72:75], v[88:91], v[36:39]
    ds_read_b64_tr_b16 v[70:71], v130 offset:24928
    v_mfma_f32_16x16x32_bf16 v[32:35], v[72:75], v[84:87], v[32:35]
    ds_read_b64_tr_b16 v[72:73], v130 offset:21632
    s_waitcnt lgkmcnt(13)
    v_mfma_f32_16x16x32_bf16 v[44:47], v[76:79], v[88:91], v[44:47]
    ds_read_b64_tr_b16 v[74:75], v130 offset:24960
    v_mfma_f32_16x16x32_bf16 v[40:43], v[76:79], v[84:87], v[40:43]
    ds_read_b64_tr_b16 v[76:77], v130 offset:21664
    s_waitcnt lgkmcnt(13)
    v_mfma_f32_16x16x32_bf16 v[52:55], v[80:83], v[88:91], v[52:55]
    ds_read_b64_tr_b16 v[78:79], v130 offset:24992
    v_mfma_f32_16x16x32_bf16 v[48:51], v[80:83], v[84:87], v[48:51]
    ds_read_b64_tr_b16 v[80:81], v130 offset:21696
    s_add_u32 m0, s56, 129024
    v_lshl_add_u32 v120, v120, 6, v136
    buffer_load_dwordx4 v120, s[8:11], 0 offen lds
    s_add_u32 s54, s54, 53248
    s_cmp_lg_u32 s58, 0
    s_cbranch_scc1 L_np_33
    s_add_u32 m0, s57, 129024
    s_nop 0
    buffer_load_dwordx4 v129, s[12:15], s54 offen lds
L_np_33:
    s_add_u32 m0, s55, 129024
    s_nop 0
    buffer_load_dwordx4 v128, s[12:15], s54 offen lds
    s_waitcnt vmcnt(8)
    s_barrier
    s_waitcnt lgkmcnt(10)
    v_mfma_f32_16x16x32_bf16 v[4:7], v[56:59], v[96:99], v[4:7]
    ds_read_b64_tr_b16 v[82:83], v130 offset:25024
    v_mfma_f32_16x16x32_bf16 v[0:3], v[56:59], v[92:95], v[0:3]
    ds_read_b64_tr_b16 v[56:57], v130 offset:43008
    s_waitcnt lgkmcnt(11)
    v_mfma_f32_16x16x32_bf16 v[12:15], v[60:63], v[96:99], v[12:15]
    ds_read_b64_tr_b16 v[58:59], v130 offset:46336
    v_mfma_f32_16x16x32_bf16 v[8:11], v[60:63], v[92:95], v[8:11]
    ds_read_b64_tr_b16 v[60:61], v130 offset:43040
    ds_read_b128 v[84:87], v133 offset:43008
    ds_read_b128 v[88:91], v133 offset:44032
    s_waitcnt lgkmcnt(13)
    v_mfma_f32_16x16x32_bf16 v[20:23], v[64:67], v[96:99], v[20:23]
    ds_read_b64_tr_b16 v[62:63], v130 offset:46368
    v_mfma_f32_16x16x32_bf16 v[16:19], v[64:67], v[92:95], v[16:19]
    ds_read_b64_tr_b16 v[64:65], v130 offset:43072
    s_waitcnt lgkmcnt(13)
    v_mfma_f32_16x16x32_bf16 v[28:31], v[68:71], v[96:99], v[28:31]
    ds_read_b64_tr_b16 v[66:67], v130 offset:46400
    v_mfma_f32_16x16x32_bf16 v[24:27], v[68:71], v[92:95], v[24:27]
    ds_read_b64_tr_b16 v[68:69], v130 offset:43104
    s_waitcnt lgkmcnt(13)
    v_mfma_f32_16x16x32_bf16 v[36:39], v[72:75], v[96:99], v[36:39]
    ds_read_b64_tr_b16 v[70:71], v130 offset:46432
    v_mfma_f32_16x16x32_bf16 v[32:35], v[72:75], v[92:95], v[32:35]
    ds_read_b64_tr_b16 v[72:73], v130 offset:43136
    s_waitcnt lgkmcnt(13)
    v_mfma_f32_16x16x32_bf16 v[44:47], v[76:79], v[96:99], v[44:47]
    ds_read_b64_tr_b16 v[74:75], v130 offset:46464
    v_mfma_f32_16x16x32_bf16 v[40:43], v[76:79], v[92:95], v[40:43]
    ds_read_b64_tr_b16 v[76:77], v130 offset:43168
    s_waitcnt lgkmcnt(13)
    v_mfma_f32_16x16x32_bf16 v[52:55], v[80:83], v[96:99], v[52:55]
    ds_read_b64_tr_b16 v[78:79], v130 offset:46496
    v_mfma_f32_16x16x32_bf16 v[48:51], v[80:83], v[92:95], v[48:51]
    ds_read_b64_tr_b16 v[80:81], v130 offset:43200
    s_add_u32 m0, s56, 0
    v_lshl_add_u32 v121, v121, 6, v136
    buffer_load_dwordx4 v121, s[8:11], 0 offen lds
    s_add_u32 s54, s54, 53248
    s_cmp_lg_u32 s58, 1
    s_cbranch_scc1 L_np_34
    s_add_u32 m0, s57, 0
    s_nop 0
    buffer_load_dwordx4 v129, s[12:15], s54 offen lds
L_np_34:
    s_add_u32 m0, s55, 0
    s_nop 0
    buffer_load_dwordx4 v128, s[12:15], s54 offen lds
    s_waitcnt vmcnt(8)
    s_barrier
    s_waitcnt lgkmcnt(10)
    v_mfma_f32_16x16x32_bf16 v[4:7], v[56:59], v[88:91], v[4:7]
    ds_read_b64_tr_b16 v[82:83], v130 offset:46528
    v_mfma_f32_16x16x32_bf16 v[0:3], v[56:59], v[84:87], v[0:3]
    ds_read_b64_tr_b16 v[56:57], v131 offset:0
    s_waitcnt lgkmcnt(11)
    v_mfma_f32_16x16x32_bf16 v[12:15], v[60:63], v[88:91], v[12:15]
    ds_read_b64_tr_b16 v[58:59], v131 offset:3328
    v_mfma_f32_16x16x32_bf16 v[8:11], v[60:63], v[84:87], v[8:11]
    ds_read_b64_tr_b16 v[60:61], v131 offset:32
    ds_read_b128 v[92:95], v134 offset:0
    ds_read_b128 v[96:99], v134 offset:1024
    s_waitcnt lgkmcnt(13)
    v_mfma_f32_16x16x32_bf16 v[20:23], v[64:67], v[88:91], v[20:23]
    ds_read_b64_tr_b16 v[62:63], v131 offset:3360
    v_mfma_f32_16x16x32_bf16 v[16:19], v[64:67], v[84:87], v[16:19]
    ds_read_b64_tr_b16 v[64:65], v131 offset:64
    s_waitcnt lgkmcnt(13)
    v_mfma_f32_16x16x32_bf16 v[28:31], v[68:71], v[88:91], v[28:31]
    ds_read_b64_tr_b16 v[66:67], v131 offset:3392
    v_mfma_f32_16x16x32_bf16 v[24:27], v[68:71], v[84:87], v[24:27]
    ds_read_b64_tr_b16 v[68:69], v131 offset:96
    s_waitcnt lgkmcnt(13)
    v_mfma_f32_16x16x32_bf16 v[36:39], v[72:75], v[88:91], v[36:39]
    ds_read_b64_tr_b16 v[70:71], v131 offset:3424
    v_mfma_f32_16x16x32_bf16 v[32:35], v[72:75], v[84:87], v[32:35]
    ds_read_b64_tr_b16 v[72:73], v131 offset:128
    s_waitcnt lgkmcnt(13)
    v_mfma_f32_16x16x32_bf16 v[44:47], v[76:79], v[88:91], v[44:47]
    ds_read_b64_tr_b16 v[74:75], v131 offset:3456
    v_mfma_f32_16x16x32_bf16 v[40:43], v[76:79], v[84:87], v[40:43]
    ds_read_b64_tr_b16 v[76:77], v131 offset:160
    s_waitcnt lgkmcnt(13)
    v_mfma_f32_16x16x32_bf16 v[52:55], v[80:83], v[88:91], v[52:55]
    ds_read_b64_tr_b16 v[78:79], v131 offset:3488
    v_mfma_f32_16x16x32_bf16 v[48:51], v[80:83], v[84:87], v[48:51]
    ds_read_b64_tr_b16 v[80:81], v131 offset:192
    s_add_u32 m0, s56, 21504
    v_lshl_add_u32 v122, v122, 6, v136
    buffer_load_dwordx4 v122, s[8:11], 0 offen lds
    s_add_u32 s54, s54, 53248
    s_cmp_lg_u32 s58, 2
    s_cbranch_scc1 L_np_35
    s_add_u32 m0, s57, 21504
    s_nop 0
    buffer_load_dwordx4 v129, s[12:15], s54 offen lds
L_np_35:
    s_add_u32 m0, s55, 21504
    s_nop 0
    buffer_load_dwordx4 v128, s[12:15], s54 offen lds
    s_waitcnt vmcnt(8)
    s_barrier
    s_waitcnt lgkmcnt(10)
    v_mfma_f32_16x16x32_bf16 v[4:7], v[56:59], v[96:99], v[4:7]
    ds_read_b64_tr_b16 v[82:83], v131 offset:3520
    v_mfma_f32_16x16x32_bf16 v[0:3], v[56:59], v[92:95], v[0:3]
    ds_read_b64_tr_b16 v[56:57], v131 offset:21504
    s_waitcnt lgkmcnt(11)
    v_mfma_f32_16x16x32_bf16 v[12:15], v[60:63], v[96:99], v[12:15]
    ds_read_b64_tr_b16 v[58:59], v131 offset:24832
    v_mfma_f32_16x16x32_bf16 v[8:11], v[60:63], v[92:95], v[8:11]
    ds_read_b64_tr_b16 v[60:61], v131 offset:21536
    ds_read_b128 v[84:87], v134 offset:21504
    ds_read_b128 v[88:91], v134 offset:22528
    s_waitcnt lgkmcnt(13)
    v_mfma_f32_16x16x32_bf16 v[20:23], v[64:67], v[96:99], v[20:23]
    ds_read_b64_tr_b16 v[62:63], v131 offset:24864
    v_mfma_f32_16x16x32_bf16 v[16:19], v[64:67], v[92:95], v[16:19]
    ds_read_b64_tr_b16 v[64:65], v131 offset:21568
    s_waitcnt lgkmcnt(13)
    v_mfma_f32_16x16x32_bf16 v[28:31], v[68:71], v[96:99], v[28:31]
    ds_read_b64_tr_b16 v[66:67], v131 offset:24896
    v_mfma_f32_16x16x32_bf16 v[24:27], v[68:71], v[92:95], v[24:27]
    ds_read_b64_tr_b16 v[68:69], v131 offset:21600
    s_waitcnt lgkmcnt(13)
    v_mfma_f32_16x16x32_bf16 v[36:39], v[72:75], v[96:99], v[36:39]
    ds_read_b64_tr_b16 v[70:71], v131 offset:24928
    v_mfma_f32_16x16x32_bf16 v[32:35], v[72:75], v[92:95], v[32:35]
    ds_read_b64_tr_b16 v[72:73], v131 offset:21632
    s_waitcnt lgkmcnt(13)
    v_mfma_f32_16x16x32_bf16 v[44:47], v[76:79], v[96:99], v[44:47]
    ds_read_b64_tr_b16 v[74:75], v131 offset:24960
    v_mfma_f32_16x16x32_bf16 v[40:43], v[76:79], v[92:95], v[40:43]
    ds_read_b64_tr_b16 v[76:77], v131 offset:21664
    s_waitcnt lgkmcnt(13)
    v_mfma_f32_16x16x32_bf16 v[52:55], v[80:83], v[96:99], v[52:55]
    ds_read_b64_tr_b16 v[78:79], v131 offset:24992
    v_mfma_f32_16x16x32_bf16 v[48:51], v[80:83], v[92:95], v[48:51]
    ds_read_b64_tr_b16 v[80:81], v131 offset:21696
    s_add_u32 m0, s56, 43008
    v_lshl_add_u32 v123, v123, 6, v136
    buffer_load_dwordx4 v123, s[8:11], 0 offen lds
    s_add_u32 s54, s54, 53248
    s_cmp_lg_u32 s58, 3
    s_cbranch_scc1 L_np_36
    s_add_u32 m0, s57, 43008
    s_nop 0
    buffer_load_dwordx4 v129, s[12:15], s54 offen lds
L_np_36:
    s_add_u32 m0, s55, 43008
    s_nop 0
    buffer_load_dwordx4 v128, s[12:15], s54 offen lds
    s_waitcnt vmcnt(8)
    s_barrier
    s_waitcnt lgkmcnt(10)
    v_mfma_f32_16x16x32_bf16 v[4:7], v[56:59], v[88:91], v[4:7]
    ds_read_b64_tr_b16 v[82:83], v131 offset:25024
    v_mfma_f32_16x16x32_bf16 v[0:3], v[56:59], v[84:87], v[0:3]
    ds_read_b64_tr_b16 v[56:57], v131 offset:43008
    s_waitcnt lgkmcnt(11)
    v_mfma_f32_16x16x32_bf16 v[12:15], v[60:63], v[88:91], v[12:15]
    ds_read_b64_tr_b16 v[58:59], v131 offset:46336
    v_mfma_f32_16x16x32_bf16 v[8:11], v[60:63], v[84:87], v[8:11]
    ds_read_b64_tr_b16 v[60:61], v131 offset:43040
    ds_read_b128 v[92:95], v134 offset:43008
    ds_read_b128 v[96:99], v134 offset:44032
    s_waitcnt lgkmcnt(13)
    v_mfma_f32_16x16x32_bf16 v[20:23], v[64:67], v[88:91], v[20:23]
    ds_read_b64_tr_b16 v[62:63], v131 offset:46368
    v_mfma_f32_16x16x32_bf16 v[16:19], v[64:67], v[84:87], v[16:19]
    ds_read_b64_tr_b16 v[64:65], v131 offset:43072
    s_waitcnt lgkmcnt(13)
    v_mfma_f32_16x16x32_bf16 v[28:31], v[68:71], v[88:91], v[28:31]
    ds_read_b64_tr_b16 v[66:67], v131 offset:46400
    v_mfma_f32_16x16x32_bf16 v[24:27], v[68:71], v[84:87], v[24:27]
    ds_read_b64_tr_b16 v[68:69], v131 offset:43104
    s_waitcnt lgkmcnt(13)
    v_mfma_f32_16x16x32_bf16 v[36:39], v[72:75], v[88:91], v[36:39]
    ds_read_b64_tr_b16 v[70:71], v131 offset:46432
    v_mfma_f32_16x16x32_bf16 v[32:35], v[72:75], v[84:87], v[32:35]
    ds_read_b64_tr_b16 v[72:73], v131 offset:43136
    s_waitcnt lgkmcnt(13)
    v_mfma_f32_16x16x32_bf16 v[44:47], v[76:79], v[88:91], v[44:47]
    ds_read_b64_tr_b16 v[74:75], v131 offset:46464
    v_mfma_f32_16x16x32_bf16 v[40:43], v[76:79], v[84:87], v[40:43]
    ds_read_b64_tr_b16 v[76:77], v131 offset:43168
    s_waitcnt lgkmcnt(13)
    v_mfma_f32_16x16x32_bf16 v[52:55], v[80:83], v[88:91], v[52:55]
    ds_read_b64_tr_b16 v[78:79], v131 offset:46496
    v_mfma_f32_16x16x32_bf16 v[48:51], v[80:83], v[84:87], v[48:51]
    ds_read_b64_tr_b16 v[80:81], v131 offset:43200
    s_add_u32 m0, s56, 64512
    v_lshl_add_u32 v124, v124, 6, v136
    buffer_load_dwordx4 v124, s[8:11], 0 offen lds
    s_add_u32 s54, s54, 53248
    s_cmp_lg_u32 s58, 0
    s_cbranch_scc1 L_np_37
    s_add_u32 m0, s57, 64512
    s_nop 0
    buffer_load_dwordx4 v129, s[12:15], s54 offen lds
L_np_37:
    s_add_u32 m0, s55, 64512
    s_nop 0
    buffer_load_dwordx4 v128, s[12:15], s54 offen lds
    s_waitcnt vmcnt(8)
    s_barrier
    s_waitcnt lgkmcnt(10)
    v_mfma_f32_16x16x32_bf16 v[4:7], v[56:59], v[96:99], v[4:7]
    ds_read_b64_tr_b16 v[82:83], v131 offset:46528
    v_mfma_f32_16x16x32_bf16 v[0:3], v[56:59], v[92:95], v[0:3]
    ds_read_b64_tr_b16 v[56:57], v132 offset:0
    s_waitcnt lgkmcnt(11)
    v_mfma_f32_16x16x32_bf16 v[12:15], v[60:63], v[96:99], v[12:15]
    ds_read_b64_tr_b16 v[58:59], v132 offset:3328
    v_mfma_f32_16x16x32_bf16 v[8:11], v[60:63], v[92:95], v[8:11]
    ds_read_b64_tr_b16 v[60:61], v132 offset:32
    ds_read_b128 v[84:87], v135 offset:0
    ds_read_b128 v[88:91], v135 offset:1024
    s_waitcnt lgkmcnt(13)
    v_mfma_f32_16x16x32_bf16 v[20:23], v[64:67], v[96:99], v[20:23]
    ds_read_b64_tr_b16 v[62:63], v132 offset:3360
    v_mfma_f32_16x16x32_bf16 v[16:19], v[64:67], v[92:95], v[16:19]
    ds_read_b64_tr_b16 v[64:65], v132 offset:64
    s_waitcnt lgkmcnt(13)
    v_mfma_f32_16x16x32_bf16 v[28:31], v[68:71], v[96:99], v[28:31]
    ds_read_b64_tr_b16 v[66:67], v132 offset:3392
    v_mfma_f32_16x16x32_bf16 v[24:27], v[68:71], v[92:95], v[24:27]
    ds_read_b64_tr_b16 v[68:69], v132 offset:96
    s_waitcnt lgkmcnt(13)
    v_mfma_f32_16x16x32_bf16 v[36:39], v[72:75], v[96:99], v[36:39]
    ds_read_b64_tr_b16 v[70:71], v132 offset:3424
    v_mfma_f32_16x16x32_bf16 v[32:35], v[72:75], v[92:95], v[32:35]
    ds_read_b64_tr_b16 v[72:73], v132 offset:128
    s_waitcnt lgkmcnt(13)
    v_mfma_f32_16x16x32_bf16 v[44:47], v[76:79], v[96:99], v[44:47]
    ds_read_b64_tr_b16 v[74:75], v132 offset:3456
    v_mfma_f32_16x16x32_bf16 v[40:43], v[76:79], v[92:95], v[40:43]
    ds_read_b64_tr_b16 v[76:77], v132 offset:160
    s_waitcnt lgkmcnt(13)
    v_mfma_f32_16x16x32_bf16 v[52:55], v[80:83], v[96:99], v[52:55]
    ds_read_b64_tr_b16 v[78:79], v132 offset:3488
    v_mfma_f32_16x16x32_bf16 v[48:51], v[80:83], v[92:95], v[48:51]
    ds_read_b64_tr_b16 v[80:81], v132 offset:192
    s_add_u32 m0, s56, 86016
    v_lshl_add_u32 v125, v125, 6, v136
    buffer_load_dwordx4 v125, s[8:11], 0 offen lds
    s_add_u32 s54, s54, 53248
    s_cmp_lg_u32 s58, 1
    s_cbranch_scc1 L_np_38
    s_add_u32 m0, s57, 86016
    s_nop 0
    buffer_load_dwordx4 v129, s[12:15], s54 offen lds
L_np_38:
    s_add_u32 m0, s55, 86016
    s_nop 0
    buffer_load_dwordx4 v128, s[12:15], s54 offen lds
    s_waitcnt vmcnt(8)
    s_barrier
    s_waitcnt lgkmcnt(10)
    v_mfma_f32_16x16x32_bf16 v[4:7], v[56:59], v[88:91], v[4:7]
    ds_read_b64_tr_b16 v[82:83], v132 offset:3520
    v_mfma_f32_16x16x32_bf16 v[0:3], v[56:59], v[84:87], v[0:3]
    ds_read_b64_tr_b16 v[56:57], v130 offset:0
    s_waitcnt lgkmcnt(11)
    v_mfma_f32_16x16x32_bf16 v[12:15], v[60:63], v[88:91], v[12:15]
    ds_read_b64_tr_b16 v[58:59], v130 offset:3328
    v_mfma_f32_16x16x32_bf16 v[8:11], v[60:63], v[84:87], v[8:11]
    ds_read_b64_tr_b16 v[60:61], v130 offset:32
    ds_read_b128 v[92:95], v133 offset:0
    ds_read_b128 v[96:99], v133 offset:1024
    s_waitcnt lgkmcnt(13)
    v_mfma_f32_16x16x32_bf16 v[20:23], v[64:67], v[88:91], v[20:23]
    ds_read_b64_tr_b16 v[62:63], v130 offset:3360
    v_mfma_f32_16x16x32_bf16 v[16:19], v[64:67], v[84:87], v[16:19]
    ds_read_b64_tr_b16 v[64:65], v130 offset:64
    s_waitcnt lgkmcnt(13)
    v_mfma_f32_16x16x32_bf16 v[28:31], v[68:71], v[88:91], v[28:31]
    ds_read_b64_tr_b16 v[66:67], v130 offset:3392
    v_mfma_f32_16x16x32_bf16 v[24:27], v[68:71], v[84:87], v[24:27]
    ds_read_b64_tr_b16 v[68:69], v130 offset:96
    s_waitcnt lgkmcnt(13)
    v_mfma_f32_16x16x32_bf16 v[36:39], v[72:75], v[88:91], v[36:39]
    ds_read_b64_tr_b16 v[70:71], v130 offset:3424
    v_mfma_f32_16x16x32_bf16 v[32:35], v[72:75], v[84:87], v[32:35]
    ds_read_b64_tr_b16 v[72:73], v130 offset:128
    s_waitcnt lgkmcnt(13)
    v_mfma_f32_16x16x32_bf16 v[44:47], v[76:79], v[88:91], v[44:47]
    ds_read_b64_tr_b16 v[74:75], v130 offset:3456
    v_mfma_f32_16x16x32_bf16 v[40:43], v[76:79], v[84:87], v[40:43]
    ds_read_b64_tr_b16 v[76:77], v130 offset:160
    s_waitcnt lgkmcnt(13)
    v_mfma_f32_16x16x32_bf16 v[52:55], v[80:83], v[88:91], v[52:55]
    ds_read_b64_tr_b16 v[78:79], v130 offset:3488
    v_mfma_f32_16x16x32_bf16 v[48:51], v[80:83], v[84:87], v[48:51]
    ds_read_b64_tr_b16 v[80:81], v130 offset:192
    s_waitcnt vmcnt(6)
    s_barrier
    s_waitcnt lgkmcnt(10)
    v_mfma_f32_16x16x32_bf16 v[4:7], v[56:59], v[96:99], v[4:7]
    ds_read_b64_tr_b16 v[82:83], v130 offset:3520
    v_mfma_f32_16x16x32_bf16 v[0:3], v[56:59], v[92:95], v[0:3]
    ds_read_b64_tr_b16 v[56:57], v130 offset:21504
    ds_read_b64 v[200:201], v138 offset:1664
    s_waitcnt lgkmcnt(12)
    v_mfma_f32_16x16x32_bf16 v[12:15], v[60:63], v[96:99], v[12:15]
    ds_read_b64_tr_b16 v[58:59], v130 offset:24832
    v_mfma_f32_16x16x32_bf16 v[8:11], v[60:63], v[92:95], v[8:11]
    ds_read_b64_tr_b16 v[60:61], v130 offset:21536
    ds_read_b128 v[84:87], v133 offset:21504
    ds_read_b128 v[88:91], v133 offset:22528
    ds_read_b64 v[202:203], v138 offset:1696
    s_waitcnt lgkmcnt(15)
    v_mfma_f32_16x16x32_bf16 v[20:23], v[64:67], v[96:99], v[20:23]
    ds_read_b64_tr_b16 v[62:63], v130 offset:24864
    v_mfma_f32_16x16x32_bf16 v[16:19], v[64:67], v[92:95], v[16:19]
    ds_read_b64_tr_b16 v[64:65], v130 offset:21568
    ds_read_b64 v[204:205], v138 offset:1728
    s_waitcnt lgkmcnt(15)
    v_mfma_f32_16x16x32_bf16 v[28:31], v[68:71], v[96:99], v[28:31]
    ds_read_b64_tr_b16 v[66:67], v130 offset:24896
    v_mfma_f32_16x16x32_bf16 v[24:27], v[68:71], v[92:95], v[24:27]
    ds_read_b64_tr_b16 v[68:69], v130 offset:21600
    ds_read_b64 v[206:207], v138 offset:1760
    s_waitcnt lgkmcnt(15)
    v_mfma_f32_16x16x32_bf16 v[36:39], v[72:75], v[96:99], v[36:39]
    ds_read_b64_tr_b16 v[70:71], v130 offset:24928
    v_mfma_f32_16x16x32_bf16 v[32:35], v[72:75], v[92:95], v[32:35]
    ds_read_b64_tr_b16 v[72:73], v130 offset:21632
    ds_read_b64 v[208:209], v138 offset:1792
    v_mfma_f32_16x16x32_bf16 v[44:47], v[76:79], v[96:99], v[44:47]
    ds_read_b64_tr_b16 v[74:75], v130 offset:24960
    v_mfma_f32_16x16x32_bf16 v[40:43], v[76:79], v[92:95], v[40:43]
    ds_read_b64_tr_b16 v[76:77], v130 offset:21664
    ds_read_b64 v[210:211], v138 offset:1824
    s_waitcnt lgkmcnt(15)
    v_mfma_f32_16x16x32_bf16 v[52:55], v[80:83], v[96:99], v[52:55]
    ds_read_b64_tr_b16 v[78:79], v130 offset:24992
    v_mfma_f32_16x16x32_bf16 v[48:51], v[80:83], v[92:95], v[48:51]
    ds_read_b64_tr_b16 v[80:81], v130 offset:21696
    ds_read_b64 v[212:213], v138 offset:1856
    s_waitcnt vmcnt(0)
    s_barrier
    s_waitcnt lgkmcnt(15)
    v_mfma_f32_16x16x32_bf16 v[4:7], v[56:59], v[88:91], v[4:7]
    ds_read_b64_tr_b16 v[82:83], v130 offset:25024
    v_mfma_f32_16x16x32_bf16 v[0:3], v[56:59], v[84:87], v[0:3]
    ds_read_b64_tr_b16 v[56:57], v130 offset:43008
    s_waitcnt lgkmcnt(15)
    v_mfma_f32_16x16x32_bf16 v[12:15], v[60:63], v[88:91], v[12:15]
    ds_read_b64_tr_b16 v[58:59], v130 offset:46336
    v_mfma_f32_16x16x32_bf16 v[8:11], v[60:63], v[84:87], v[8:11]
    ds_read_b64_tr_b16 v[60:61], v130 offset:43040
    ds_read_b128 v[92:95], v133 offset:43008
    ds_read_b128 v[96:99], v133 offset:44032
    s_waitcnt lgkmcnt(15)
    v_mfma_f32_16x16x32_bf16 v[20:23], v[64:67], v[88:91], v[20:23]
    ds_read_b64_tr_b16 v[62:63], v130 offset:46368
    v_mfma_f32_16x16x32_bf16 v[16:19], v[64:67], v[84:87], v[16:19]
    ds_read_b64_tr_b16 v[64:65], v130 offset:43072
    s_waitcnt lgkmcnt(15)
    v_mfma_f32_16x16x32_bf16 v[28:31], v[68:71], v[88:91], v[28:31]
    ds_read_b64_tr_b16 v[66:67], v130 offset:46400
    v_mfma_f32_16x16x32_bf16 v[24:27], v[68:71], v[84:87], v[24:27]
    ds_read_b64_tr_b16 v[68:69], v130 offset:43104
    s_waitcnt lgkmcnt(15)
    v_mfma_f32_16x16x32_bf16 v[36:39], v[72:75], v[88:91], v[36:39]
    ds_read_b64_tr_b16 v[70:71], v130 offset:46432
    v_mfma_f32_16x16x32_bf16 v[32:35], v[72:75], v[84:87], v[32:35]
    ds_read_b64_tr_b16 v[72:73], v130 offset:43136
    s_waitcnt lgkmcnt(14)
    v_mfma_f32_16x16x32_bf16 v[44:47], v[76:79], v[88:91], v[44:47]
    ds_read_b64_tr_b16 v[74:75], v130 offset:46464
    v_mfma_f32_16x16x32_bf16 v[40:43], v[76:79], v[84:87], v[40:43]
    ds_read_b64_tr_b16 v[76:77], v130 offset:43168
    s_waitcnt lgkmcnt(13)
    v_mfma_f32_16x16x32_bf16 v[52:55], v[80:83], v[88:91], v[52:55]
    ds_read_b64_tr_b16 v[78:79], v130 offset:46496
    v_mfma_f32_16x16x32_bf16 v[48:51], v[80:83], v[84:87], v[48:51]
    ds_read_b64_tr_b16 v[80:81], v130 offset:43200
    s_waitcnt lgkmcnt(10)
    v_mfma_f32_16x16x32_bf16 v[4:7], v[56:59], v[96:99], v[4:7]
    ds_read_b64_tr_b16 v[82:83], v130 offset:46528
    v_mfma_f32_16x16x32_bf16 v[0:3], v[56:59], v[92:95], v[0:3]
    ds_read_b64_tr_b16 v[56:57], v131 offset:0
    v_lshlrev_b32 v170, 16, v200
    v_and_b32 v171, 0xffff0000, v200
    v_lshlrev_b32 v172, 16, v201
    s_waitcnt lgkmcnt(11)
    v_mfma_f32_16x16x32_bf16 v[12:15], v[60:63], v[96:99], v[12:15]
    ds_read_b64_tr_b16 v[58:59], v131 offset:3328
    v_mfma_f32_16x16x32_bf16 v[8:11], v[60:63], v[92:95], v[8:11]
    ds_read_b64_tr_b16 v[60:61], v131 offset:32
    ds_read_b128 v[84:87], v134 offset:0
    ds_read_b128 v[88:91], v134 offset:1024
    v_and_b32 v173, 0xffff0000, v201
    v_lshlrev_b32 v174, 16, v202
    v_and_b32 v175, 0xffff0000, v202
    s_waitcnt lgkmcnt(13)
    v_mfma_f32_16x16x32_bf16 v[20:23], v[64:67], v[96:99], v[20:23]
    ds_read_b64_tr_b16 v[62:63], v131 offset:3360
    v_mfma_f32_16x16x32_bf16 v[16:19], v[64:67], v[92:95], v[16:19]
    ds_read_b64_tr_b16 v[64:65], v131 offset:64
    v_lshlrev_b32 v176, 16, v203
    v_and_b32 v177, 0xffff0000, v203
    v_lshlrev_b32 v178, 16, v204
    s_waitcnt lgkmcnt(13)
    v_mfma_f32_16x16x32_bf16 v[28:31], v[68:71], v[96:99], v[28:31]
    ds_read_b64_tr_b16 v[66:67], v131 offset:3392
    v_mfma_f32_16x16x32_bf16 v[24:27], v[68:71], v[92:95], v[24:27]
    ds_read_b64_tr_b16 v[68:69], v131 offset:96
    v_and_b32 v179, 0xffff0000, v204
    v_lshlrev_b32 v180, 16, v205
    v_and_b32 v181, 0xffff0000, v205
    s_waitcnt lgkmcnt(13)
    v_mfma_f32_16x16x32_bf16 v[36:39], v[72:75], v[96:99], v[36:39]
    ds_read_b64_tr_b16 v[70:71], v131 offset:3424
    v_mfma_f32_16x16x32_bf16 v[32:35], v[72:75], v[92:95], v[32:35]
    ds_read_b64_tr_b16 v[72:73], v131 offset:128
    v_lshlrev_b32 v182, 16, v206
    v_and_b32 v183, 0xffff0000, v206
    v_lshlrev_b32 v184, 16, v207
    s_waitcnt lgkmcnt(13)
    v_mfma_f32_16x16x32_bf16 v[44:47], v[76:79], v[96:99], v[44:47]
    ds_read_b64_tr_b16 v[74:75], v131 offset:3456
    v_mfma_f32_16x16x32_bf16 v[40:43], v[76:79], v[92:95], v[40:43]
    ds_read_b64_tr_b16 v[76:77], v131 offset:160
    v_and_b32 v185, 0xffff0000, v207
    v_lshlrev_b32 v186, 16, v208
    v_and_b32 v187, 0xffff0000, v208
    s_waitcnt lgkmcnt(13)
    v_mfma_f32_16x16x32_bf16 v[52:55], v[80:83], v[96:99], v[52:55]
    ds_read_b64_tr_b16 v[78:79], v131 offset:3488
    v_mfma_f32_16x16x32_bf16 v[48:51], v[80:83], v[92:95], v[48:51]
    ds_read_b64_tr_b16 v[80:81], v131 offset:192
    v_lshlrev_b32 v188, 16, v209
    v_and_b32 v189, 0xffff0000, v209
    v_lshlrev_b32 v190, 16, v210
    s_waitcnt lgkmcnt(10)
    v_mfma_f32_16x16x32_bf16 v[4:7], v[56:59], v[88:91], v[4:7]
    ds_read_b64_tr_b16 v[82:83], v131 offset:3520
    v_mfma_f32_16x16x32_bf16 v[0:3], v[56:59], v[84:87], v[0:3]
    ds_read_b64_tr_b16 v[56:57], v131 offset:21504
    v_and_b32 v191, 0xffff0000, v210
    v_lshlrev_b32 v192, 16, v211
    v_and_b32 v193, 0xffff0000, v211
    s_waitcnt lgkmcnt(11)
    v_mfma_f32_16x16x32_bf16 v[12:15], v[60:63], v[88:91], v[12:15]
    ds_read_b64_tr_b16 v[58:59], v131 offset:24832
    v_mfma_f32_16x16x32_bf16 v[8:11], v[60:63], v[84:87], v[8:11]
    ds_read_b64_tr_b16 v[60:61], v131 offset:21536
    ds_read_b128 v[92:95], v134 offset:21504
    ds_read_b128 v[96:99], v134 offset:22528
    v_lshlrev_b32 v194, 16, v212
    v_and_b32 v195, 0xffff0000, v212
    v_lshlrev_b32 v196, 16, v213
    s_waitcnt lgkmcnt(13)
    v_mfma_f32_16x16x32_bf16 v[20:23], v[64:67], v[88:91], v[20:23]
    ds_read_b64_tr_b16 v[62:63], v131 offset:24864
    v_mfma_f32_16x16x32_bf16 v[16:19], v[64:67], v[84:87], v[16:19]
    ds_read_b64_tr_b16 v[64:65], v131 offset:21568
    v_and_b32 v197, 0xffff0000, v213
    s_waitcnt lgkmcnt(13)
    v_mfma_f32_16x16x32_bf16 v[28:31], v[68:71], v[88:91], v[28:31]
    ds_read_b64_tr_b16 v[66:67], v131 offset:24896
    v_mfma_f32_16x16x32_bf16 v[24:27], v[68:71], v[84:87], v[24:27]
    ds_read_b64_tr_b16 v[68:69], v131 offset:21600
    s_waitcnt lgkmcnt(13)
    v_mfma_f32_16x16x32_bf16 v[36:39], v[72:75], v[88:91], v[36:39]
    ds_read_b64_tr_b16 v[70:71], v131 offset:24928
    v_mfma_f32_16x16x32_bf16 v[32:35], v[72:75], v[84:87], v[32:35]
    ds_read_b64_tr_b16 v[72:73], v131 offset:21632
    s_waitcnt lgkmcnt(13)
    v_mfma_f32_16x16x32_bf16 v[44:47], v[76:79], v[88:91], v[44:47]
    ds_read_b64_tr_b16 v[74:75], v131 offset:24960
    v_mfma_f32_16x16x32_bf16 v[40:43], v[76:79], v[84:87], v[40:43]
    ds_read_b64_tr_b16 v[76:77], v131 offset:21664
    s_waitcnt lgkmcnt(13)
    v_mfma_f32_16x16x32_bf16 v[52:55], v[80:83], v[88:91], v[52:55]
    ds_read_b64_tr_b16 v[78:79], v131 offset:24992
    v_mfma_f32_16x16x32_bf16 v[48:51], v[80:83], v[84:87], v[48:51]
    ds_read_b64_tr_b16 v[80:81], v131 offset:21696
    s_waitcnt lgkmcnt(10)
    v_mfma_f32_16x16x32_bf16 v[4:7], v[56:59], v[96:99], v[4:7]
    ds_read_b64_tr_b16 v[82:83], v131 offset:25024
    v_mfma_f32_16x16x32_bf16 v[0:3], v[56:59], v[92:95], v[0:3]
    s_waitcnt lgkmcnt(10)
    v_mfma_f32_16x16x32_bf16 v[12:15], v[60:63], v[96:99], v[12:15]
    v_mfma_f32_16x16x32_bf16 v[8:11], v[60:63], v[92:95], v[8:11]
    s_waitcnt lgkmcnt(8)
    v_mfma_f32_16x16x32_bf16 v[20:23], v[64:67], v[96:99], v[20:23]
    v_mfma_f32_16x16x32_bf16 v[16:19], v[64:67], v[92:95], v[16:19]
    s_waitcnt lgkmcnt(6)
    v_mfma_f32_16x16x32_bf16 v[28:31], v[68:71], v[96:99], v[28:31]
    v_mfma_f32_16x16x32_bf16 v[24:27], v[68:71], v[92:95], v[24:27]
    s_waitcnt lgkmcnt(4)
    v_mfma_f32_16x16x32_bf16 v[36:39], v[72:75], v[96:99], v[36:39]
    v_mfma_f32_16x16x32_bf16 v[32:35], v[72:75], v[92:95], v[32:35]
    s_waitcnt lgkmcnt(2)
    v_mfma_f32_16x16x32_bf16 v[44:47], v[76:79], v[96:99], v[44:47]
    v_mfma_f32_16x16x32_bf16 v[40:43], v[76:79], v[92:95], v[40:43]
    s_waitcnt lgkmcnt(0)
    v_mfma_f32_16x16x32_bf16 v[52:55], v[80:83], v[96:99], v[52:55]
    v_mfma_f32_16x16x32_bf16 v[48:51], v[80:83], v[92:95], v[48:51]
    s_branch L_gelu
.p2align 6
L_dnn6:
    s_waitcnt vmcnt(3)
    s_barrier
    ds_read_b64 v[140:141], v138 offset:0
    ds_read_b64 v[142:143], v138 offset:32
    ds_read_b64 v[144:145], v138 offset:64
    ds_read_b64 v[146:147], v138 offset:96
    ds_read_b64 v[148:149], v138 offset:128
    ds_read_b64 v[150:151], v138 offset:160
    ds_read_b128 v[84:87], v133 offset:0
    ds_read_b128 v[88:91], v133 offset:1024
    ds_read_b64_tr_b16 v[56:57], v130 offset:0
    ds_read_b64_tr_b16 v[58:59], v130 offset:3328
    ds_read_b64_tr_b16 v[60:61], v130 offset:32
    ds_read_b64_tr_b16 v[62:63], v130 offset:3360
    ds_read_b64_tr_b16 v[64:65], v130 offset:64
    ds_read_b64_tr_b16 v[66:67], v130 offset:3392
    ds_read_b64_tr_b16 v[68:69], v130 offset:96
    ds_read_b64_tr_b16 v[70:71], v130 offset:3424
    ds_read_b64_tr_b16 v[72:73], v130 offset:128
    ds_read_b64_tr_b16 v[74:75], v130 offset:3456
    ds_read_b64_tr_b16 v[76:77], v130 offset:160
    ds_read_b64_tr_b16 v[78:79], v130 offset:3488
    s_waitcnt lgkmcnt(14)
    v_lshlrev_b32 v0, 16, v140
    v_and_b32 v1, 0xffff0000, v140
    v_lshlrev_b32 v2, 16, v141
    v_and_b32 v3, 0xffff0000, v141
    v_lshlrev_b32 v8, 16, v142
    v_and_b32 v9, 0xffff0000, v142
    v_lshlrev_b32 v10, 16, v143
    v_and_b32 v11, 0xffff0000, v143
    v_lshlrev_b32 v16, 16, v144
    v_and_b32 v17, 0xffff0000, v144
    v_lshlrev_b32 v18, 16, v145
    v_and_b32 v19, 0xffff0000, v145
    v_lshlrev_b32 v24, 16, v146
    v_and_b32 v25, 0xffff0000, v146
    v_lshlrev_b32 v26, 16, v147
    v_and_b32 v27, 0xffff0000, v147
    v_lshlrev_b32 v32, 16, v148
    v_and_b32 v33, 0xffff0000, v148
    v_lshlrev_b32 v34, 16, v149
    v_and_b32 v35, 0xffff0000, v149
    v_lshlrev_b32 v40, 16, v150
    v_and_b32 v41, 0xffff0000, v150
    v_lshlrev_b32 v42, 16, v151
    v_and_b32 v43, 0xffff0000, v151
    s_add_u32 m0, s56, 43008
    v_lshl_add_u32 v102, v102, 6, v136
    buffer_load_dwordx4 v102, s[8:11], 0 offen lds
    s_add_u32 s54, s54, 53248
    s_add_u32 m0, s57, 43008
    s_nop 0
    buffer_load_dwordx4 v129, s[12:15], s54 offen lds
    s_add_u32 m0, s55, 43008
    s_nop 0
    buffer_load_dwordx4 v128, s[12:15], s54 offen lds
    s_waitcnt vmcnt(3)
    s_barrier
    s_add_u32 m0, s56, 64512
    v_lshl_add_u32 v103, v103, 6, v136
    buffer_load_dwordx4 v103, s[8:11], 0 offen lds
    s_add_u32 s54, s54, 53248
    s_add_u32 m0, s57, 64512
    s_nop 0
    buffer_load_dwordx4 v129, s[12:15], s54 offen lds
    s_add_u32 m0, s55, 64512
    s_nop 0
    buffer_load_dwordx4 v128, s[12:15], s54 offen lds
    s_waitcnt lgkmcnt(10)
    v_mfma_f32_16x16x32_bf16 v[4:7], v[56:59], v[88:91], v[0:3]
    v_mfma_f32_16x16x32_bf16 v[0:3], v[56:59], v[84:87], v[0:3]
    ds_read_b64_tr_b16 v[56:57], v130 offset:21504
    s_waitcnt lgkmcnt(9)
    v_mfma_f32_16x16x32_bf16 v[12:15], v[60:63], v[88:91], v[8:11]
    ds_read_b64_tr_b16 v[58:59], v130 offset:24832
    v_mfma_f32_16x16x32_bf16 v[8:11], v[60:63], v[84:87], v[8:11]
    ds_read_b64_tr_b16 v[60:61], v130 offset:21536
    ds_read_b128 v[92:95], v133 offset:21504
    ds_read_b128 v[96:99], v133 offset:22528
    s_waitcnt lgkmcnt(11)
    v_mfma_f32_16x16x32_bf16 v[20:23], v[64:67], v[88:91], v[16:19]
    ds_read_b64_tr_b16 v[62:63], v130 offset:24864
    v_mfma_f32_16x16x32_bf16 v[16:19], v[64:67], v[84:87], v[16:19]
    ds_read_b64_tr_b16 v[64:65], v130 offset:21568
    s_waitcnt lgkmcnt(11)
    v_mfma_f32_16x16x32_bf16 v[28:31], v[68:71], v[88:91], v[24:27]
    ds_read_b64_tr_b16 v[66:67], v130 offset:24896
    v_mfma_f32_16x16x32_bf16 v[24:27], v[68:71], v[84:87], v[24:27]
    ds_read_b64_tr_b16 v[68:69], v130 offset:21600
    s_waitcnt lgkmcnt(11)
    v_mfma_f32_16x16x32_bf16 v[36:39], v[72:75], v[88:91], v[32:35]
    ds_read_b64_tr_b16 v[70:71], v130 offset:24928
    v_mfma_f32_16x16x32_bf16 v[32:35], v[72:75], v[84:87], v[32:35]
    ds_read_b64_tr_b16 v[72:73], v130 offset:21632
    s_waitcnt lgkmcnt(11)
    v_mfma_f32_16x16x32_bf16 v[44:47], v[76:79], v[88:91], v[40:43]
    ds_read_b64_tr_b16 v[74:75], v130 offset:24960
    v_mfma_f32_16x16x32_bf16 v[40:43], v[76:79], v[84:87], v[40:43]
    ds_read_b64_tr_b16 v[76:77], v130 offset:21664
    s_waitcnt vmcnt(3)
    s_barrier
    s_add_u32 m0, s56, 86016
    v_lshl_add_u32 v104, v104, 6, v136
    buffer_load_dwordx4 v104, s[8:11], 0 offen lds
    s_add_u32 s54, s54, 53248
    s_add_u32 m0, s57, 86016
    s_nop 0
    buffer_load_dwordx4 v129, s[12:15], s54 offen lds
    s_add_u32 m0, s55, 86016
    s_nop 0
    buffer_load_dwordx4 v128, s[12:15], s54 offen lds
    s_waitcnt lgkmcnt(8)
    v_mfma_f32_16x16x32_bf16 v[4:7], v[56:59], v[96:99], v[4:7]
    ds_read_b64_tr_b16 v[78:79], v130 offset:24992
    v_mfma_f32_16x16x32_bf16 v[0:3], v[56:59], v[92:95], v[0:3]
    ds_read_b64_tr_b16 v[56:57], v130 offset:43008
    s_waitcnt lgkmcnt(9)
    v_mfma_f32_16x16x32_bf16 v[12:15], v[60:63], v[96:99], v[12:15]
    ds_read_b64_tr_b16 v[58:59], v130 offset:46336
    v_mfma_f32_16x16x32_bf16 v[8:11], v[60:63], v[92:95], v[8:11]
    ds_read_b64_tr_b16 v[60:61], v130 offset:43040
    ds_read_b128 v[84:87], v133 offset:43008
    ds_read_b128 v[88:91], v133 offset:44032
    s_waitcnt lgkmcnt(11)
    v_mfma_f32_16x16x32_bf16 v[20:23], v[64:67], v[96:99], v[20:23]
    ds_read_b64_tr_b16 v[62:63], v130 offset:46368
    v_mfma_f32_16x16x32_bf16 v[16:19], v[64:67], v[92:95], v[16:19]
    ds_read_b64_tr_b16 v[64:65], v130 offset:43072
    s_waitcnt lgkmcnt(11)
    v_mfma_f32_16x16x32_bf16 v[28:31], v[68:71], v[96:99], v[28:31]
    ds_read_b64_tr_b16 v[66:67], v130 offset:46400
    v_mfma_f32_16x16x32_bf16 v[24:27], v[68:71], v[92:95], v[24:27]
    ds_read_b64_tr_b16 v[68:69], v130 offset:43104
    s_waitcnt lgkmcnt(11)
    v_mfma_f32_16x16x32_bf16 v[36:39], v[72:75], v[96:99], v[36:39]
    ds_read_b64_tr_b16 v[70:71], v130 offset:46432
    v_mfma_f32_16x16x32_bf16 v[32:35], v[72:75], v[92:95], v[32:35]
    ds_read_b64_tr_b16 v[72:73], v130 offset:43136
    s_waitcnt lgkmcnt(11)
    v_mfma_f32_16x16x32_bf16 v[44:47], v[76:79], v[96:99], v[44:47]
    ds_read_b64_tr_b16 v[74:75], v130 offset:46464
    v_mfma_f32_16x16x32_bf16 v[40:43], v[76:79], v[92:95], v[40:43]
    ds_read_b64_tr_b16 v[76:77], v130 offset:43168
    s_waitcnt vmcnt(3)
    s_barrier
    s_add_u32 m0, s56, 107520
    v_lshl_add_u32 v105, v105, 6, v136
    buffer_load_dwordx4 v105, s[8:11], 0 offen lds
    s_add_u32 s54, s54, 53248
    s_add_u32 m0, s57, 107520
    s_nop 0
    buffer_load_dwordx4 v129, s[12:15], s54 offen lds
    s_add_u32 m0, s55, 107520
    s_nop 0
    buffer_load_dwordx4 v128, s[12:15], s54 offen lds
    s_waitcnt lgkmcnt(8)
    v_mfma_f32_16x16x32_bf16 v[4:7], v[56:59], v[88:91], v[4:7]
    ds_read_b64_tr_b16 v[78:79], v130 offset:46496
    v_mfma_f32_16x16x32_bf16 v[0:3], v[56:59], v[84:87], v[0:3]
    ds_read_b64_tr_b16 v[56:57], v131 offset:0
    s_waitcnt lgkmcnt(9)
    v_mfma_f32_16x16x32_bf16 v[12:15], v[60:63], v[88:91], v[12:15]
    ds_read_b64_tr_b16 v[58:59], v131 offset:3328
    v_mfma_f32_16x16x32_bf16 v[8:11], v[60:63], v[84:87], v[8:11]
    ds_read_b64_tr_b16 v[60:61], v131 offset:32
    ds_read_b128 v[92:95], v134 offset:0
    ds_read_b128 v[96:99], v134 offset:1024
    s_waitcnt lgkmcnt(11)
    v_mfma_f32_16x16x32_bf16 v[20:23], v[64:67], v[88:91], v[20:23]
    ds_read_b64_tr_b16 v[62:63], v131 offset:3360
    v_mfma_f32_16x16x32_bf16 v[16:19], v[64:67], v[84:87], v[16:19]
    ds_read_b64_tr_b16 v[64:65], v131 offset:64
    s_waitcnt lgkmcnt(11)
    v_mfma_f32_16x16x32_bf16 v[28:31], v[68:71], v[88:91], v[28:31]
    ds_read_b64_tr_b16 v[66:67], v131 offset:3392
    v_mfma_f32_16x16x32_bf16 v[24:27], v[68:71], v[84:87], v[24:27]
    ds_read_b64_tr_b16 v[68:69], v131 offset:96
    s_waitcnt lgkmcnt(11)
    v_mfma_f32_16x16x32_bf16 v[36:39], v[72:75], v[88:91], v[36:39]
    ds_read_b64_tr_b16 v[70:71], v131 offset:3424
    v_mfma_f32_16x16x32_bf16 v[32:35], v[72:75], v[84:87], v[32:35]
    ds_read_b64_tr_b16 v[72:73], v131 offset:128
    s_waitcnt lgkmcnt(11)
    v_mfma_f32_16x16x32_bf16 v[44:47], v[76:79], v[88:91], v[44:47]
    ds_read_b64_tr_b16 v[74:75], v131 offset:3456
    v_mfma_f32_16x16x32_bf16 v[40:43], v[76:79], v[84:87], v[40:43]
    ds_read_b64_tr_b16 v[76:77], v131 offset:160
    s_waitcnt vmcnt(3)
    s_barrier
    s_add_u32 m0, s56, 129024
    v_lshl_add_u32 v106, v106, 6, v136
    buffer_load_dwordx4 v106, s[8:11], 0 offen lds
    s_add_u32 s54, s54, 53248
    s_add_u32 m0, s57, 129024
    s_nop 0
    buffer_load_dwordx4 v129, s[12:15], s54 offen lds
    s_add_u32 m0, s55, 129024
    s_nop 0
    buffer_load_dwordx4 v128, s[12:15], s54 offen lds
    s_waitcnt lgkmcnt(8)
    v_mfma_f32_16x16x32_bf16 v[4:7], v[56:59], v[96:99], v[4:7]
    ds_read_b64_tr_b16 v[78:79], v131 offset:3488
    v_mfma_f32_16x16x32_bf16 v[0:3], v[56:59], v[92:95], v[0:3]
    ds_read_b64_tr_b16 v[56:57], v131 offset:21504
    s_waitcnt lgkmcnt(9)
    v_mfma_f32_16x16x32_bf16 v[12:15], v[60:63], v[96:99], v[12:15]
    ds_read_b64_tr_b16 v[58:59], v131 offset:24832
    v_mfma_f32_16x16x32_bf16 v[8:11], v[60:63], v[92:95], v[8:11]
    ds_read_b64_tr_b16 v[60:61], v131 offset:21536
    ds_read_b128 v[84:87], v134 offset:21504
    ds_read_b128 v[88:91], v134 offset:22528
    s_waitcnt lgkmcnt(11)
    v_mfma_f32_16x16x32_bf16 v[20:23], v[64:67], v[96:99], v[20:23]
    ds_read_b64_tr_b16 v[62:63], v131 offset:24864
    v_mfma_f32_16x16x32_bf16 v[16:19], v[64:67], v[92:95], v[16:19]
    ds_read_b64_tr_b16 v[64:65], v131 offset:21568
    s_waitcnt lgkmcnt(11)
    v_mfma_f32_16x16x32_bf16 v[28:31], v[68:71], v[96:99], v[28:31]
    ds_read_b64_tr_b16 v[66:67], v131 offset:24896
    v_mfma_f32_16x16x32_bf16 v[24:27], v[68:71], v[92:95], v[24:27]
    ds_read_b64_tr_b16 v[68:69], v131 offset:21600
    s_waitcnt lgkmcnt(11)
    v_mfma_f32_16x16x32_bf16 v[36:39], v[72:75], v[96:99], v[36:39]
    ds_read_b64_tr_b16 v[70:71], v131 offset:24928
    v_mfma_f32_16x16x32_bf16 v[32:35], v[72:75], v[92:95], v[32:35]
    ds_read_b64_tr_b16 v[72:73], v131 offset:21632
    s_waitcnt lgkmcnt(11)
    v_mfma_f32_16x16x32_bf16 v[44:47], v[76:79], v[96:99], v[44:47]
    ds_read_b64_tr_b16 v[74:75], v131 offset:24960
    v_mfma_f32_16x16x32_bf16 v[40:43], v[76:79], v[92:95], v[40:43]
    ds_read_b64_tr_b16 v[76:77], v131 offset:21664
    s_waitcnt vmcnt(3)
    s_barrier
    s_add_u32 m0, s56, 0
    v_lshl_add_u32 v107, v107, 6, v136
    buffer_load_dwordx4 v107, s[8:11], 0 offen lds
    s_add_u32 s54, s54, 53248
    s_add_u32 m0, s57, 0
    s_nop 0
    buffer_load_dwordx4 v129, s[12:15], s54 offen lds
    s_add_u32 m0, s55, 0
    s_nop 0
    buffer_load_dwordx4 v128, s[12:15], s54 offen lds
    s_add_u32 m0, s56, 21504
    v_lshl_add_u32 v108, v108, 6, v136
    buffer_load_dwordx4 v108, s[8:11], 0 offen lds
    s_add_u32 s54, s54, 53248
    s_add_u32 m0, s57, 21504
    s_nop 0
    buffer_load_dwordx4 v129, s[12:15], s54 offen lds
    s_add_u32 m0, s55, 21504
    s_nop 0
    buffer_load_dwordx4 v128, s[12:15], s54 offen lds
    s_waitcnt lgkmcnt(8)
    v_mfma_f32_16x16x32_bf16 v[4:7], v[56:59], v[88:91], v[4:7]
    ds_read_b64_tr_b16 v[78:79], v131 offset:24992
    v_mfma_f32_16x16x32_bf16 v[0:3], v[56:59], v[84:87], v[0:3]
    ds_read_b64_tr_b16 v[56:57], v131 offset:43008
    s_waitcnt lgkmcnt(9)
    v_mfma_f32_16x16x32_bf16 v[12:15], v[60:63], v[88:91], v[12:15]
    ds_read_b64_tr_b16 v[58:59], v131 offset:46336
    v_mfma_f32_16x16x32_bf16 v[8:11], v[60:63], v[84:87], v[8:11]
    ds_read_b64_tr_b16 v[60:61], v131 offset:43040
    ds_read_b128 v[92:95], v134 offset:43008
    ds_read_b128 v[96:99], v134 offset:44032
    s_waitcnt lgkmcnt(11)
    v_mfma_f32_16x16x32_bf16 v[20:23], v[64:67], v[88:91], v[20:23]
    ds_read_b64_tr_b16 v[62:63], v131 offset:46368
    v_mfma_f32_16x16x32_bf16 v[16:19], v[64:67], v[84:87], v[16:19]
    ds_read_b64_tr_b16 v[64:65], v131 offset:43072
    s_waitcnt lgkmcnt(11)
    v_mfma_f32_16x16x32_bf16 v[28:31], v[68:71], v[88:91], v[28:31]
    ds_read_b64_tr_b16 v[66:67], v131 offset:46400
    v_mfma_f32_16x16x32_bf16 v[24:27], v[68:71], v[84:87], v[24:27]
    ds_read_b64_tr_b16 v[68:69], v131 offset:43104
    s_waitcnt lgkmcnt(11)
    v_mfma_f32_16x16x32_bf16 v[36:39], v[72:75], v[88:91], v[36:39]
    ds_read_b64_tr_b16 v[70:71], v131 offset:46432
    v_mfma_f32_16x16x32_bf16 v[32:35], v[72:75], v[84:87], v[32:35]
    ds_read_b64_tr_b16 v[72:73], v131 offset:43136
    s_waitcnt lgkmcnt(11)
    v_mfma_f32_16x16x32_bf16 v[44:47], v[76:79], v[88:91], v[44:47]
    ds_read_b64_tr_b16 v[74:75], v131 offset:46464
    v_mfma_f32_16x16x32_bf16 v[40:43], v[76:79], v[84:87], v[40:43]
    ds_read_b64_tr_b16 v[76:77], v131 offset:43168
    s_waitcnt vmcnt(6)
    s_barrier
    s_add_u32 m0, s56, 43008
    v_lshl_add_u32 v109, v109, 6, v136
    buffer_load_dwordx4 v109, s[8:11], 0 offen lds
    s_add_u32 s54, s54, 53248
    s_add_u32 m0, s57, 43008
    s_nop 0
    buffer_load_dwordx4 v129, s[12:15], s54 offen lds
    s_add_u32 m0, s55, 43008
    s_nop 0
    buffer_load_dwordx4 v128, s[12:15], s54 offen lds
    s_add_u32 m0, s56, 64512
    v_lshl_add_u32 v110, v110, 6, v136
    buffer_load_dwordx4 v110, s[8:11], 0 offen lds
    s_add_u32 s54, s54, 53248
    s_add_u32 m0, s57, 64512
    s_nop 0
    buffer_load_dwordx4 v129, s[12:15], s54 offen lds
    s_add_u32 m0, s55, 64512
    s_nop 0
    buffer_load_dwordx4 v128, s[12:15], s54 offen lds
    s_waitcnt lgkmcnt(8)
    v_mfma_f32_16x16x32_bf16 v[4:7], v[56:59], v[96:99], v[4:7]
    ds_read_b64_tr_b16 v[78:79], v131 offset:46496
    v_mfma_f32_16x16x32_bf16 v[0:3], v[56:59], v[92:95], v[0:3]
    ds_read_b64_tr_b16 v[56:57], v132 offset:0
    s_waitcnt lgkmcnt(9)
    v_mfma_f32_16x16x32_bf16 v[12:15], v[60:63], v[96:99], v[12:15]
    ds_read_b64_tr_b16 v[58:59], v132 offset:3328
    v_mfma_f32_16x16x32_bf16 v[8:11], v[60:63], v[92:95], v[8:11]
    ds_read_b64_tr_b16 v[60:61], v132 offset:32
    ds_read_b128 v[84:87], v135 offset:0
    ds_read_b128 v[88:91], v135 offset:1024
    s_waitcnt lgkmcnt(11)
    v_mfma_f32_16x16x32_bf16 v[20:23], v[64:67], v[96:99], v[20:23]
    ds_read_b64_tr_b16 v[62:63], v132 offset:3360
    v_mfma_f32_16x16x32_bf16 v[16:19], v[64:67], v[92:95], v[16:19]
    ds_read_b64_tr_b16 v[64:65], v132 offset:64
    s_waitcnt lgkmcnt(11)
    v_mfma_f32_16x16x32_bf16 v[28:31], v[68:71], v[96:99], v[28:31]
    ds_read_b64_tr_b16 v[66:67], v132 offset:3392
    v_mfma_f32_16x16x32_bf16 v[24:27], v[68:71], v[92:95], v[24:27]
    ds_read_b64_tr_b16 v[68:69], v132 offset:96
    s_waitcnt lgkmcnt(11)
    v_mfma_f32_16x16x32_bf16 v[36:39], v[72:75], v[96:99], v[36:39]
    ds_read_b64_tr_b16 v[70:71], v132 offset:3424
    v_mfma_f32_16x16x32_bf16 v[32:35], v[72:75], v[92:95], v[32:35]
    ds_read_b64_tr_b16 v[72:73], v132 offset:128
    s_waitcnt lgkmcnt(11)
    v_mfma_f32_16x16x32_bf16 v[44:47], v[76:79], v[96:99], v[44:47]
    ds_read_b64_tr_b16 v[74:75], v132 offset:3456
    v_mfma_f32_16x16x32_bf16 v[40:43], v[76:79], v[92:95], v[40:43]
    ds_read_b64_tr_b16 v[76:77], v132 offset:160
    s_waitcnt vmcnt(9)
    s_barrier
    s_add_u32 m0, s56, 86016
    v_lshl_add_u32 v111, v111, 6, v136
    buffer_load_dwordx4 v111, s[8:11], 0 offen lds
    s_add_u32 s54, s54, 53248
    s_add_u32 m0, s57, 86016
    s_nop 0
    buffer_load_dwordx4 v129, s[12:15], s54 offen lds
    s_add_u32 m0, s55, 86016
    s_nop 0
    buffer_load_dwordx4 v128, s[12:15], s54 offen lds
    s_add_u32 m0, s56, 107520
    v_lshl_add_u32 v112, v112, 6, v136
    buffer_load_dwordx4 v112, s[8:11], 0 offen lds
    s_add_u32 s54, s54, 53248
    s_add_u32 m0, s57, 107520
    s_nop 0
    buffer_load_dwordx4 v129, s[12:15], s54 offen lds
    s_add_u32 m0, s55, 107520
    s_nop 0
    buffer_load_dwordx4 v128, s[12:15], s54 offen lds
    s_waitcnt lgkmcnt(8)
    v_mfma_f32_16x16x32_bf16 v[4:7], v[56:59], v[88:91], v[4:7]
    ds_read_b64_tr_b16 v[78:79], v132 offset:3488
    v_mfma_f32_16x16x32_bf16 v[0:3], v[56:59], v[84:87], v[0:3]
    ds_read_b64_tr_b16 v[56:57], v130 offset:0
    s_waitcnt lgkmcnt(9)
    v_mfma_f32_16x16x32_bf16 v[12:15], v[60:63], v[88:91], v[12:15]
    ds_read_b64_tr_b16 v[58:59], v130 offset:3328
    v_mfma_f32_16x16x32_bf16 v[8:11], v[60:63], v[84:87], v[8:11]
    ds_read_b64_tr_b16 v[60:61], v130 offset:32
    ds_read_b128 v[92:95], v133 offset:0
    ds_read_b128 v[96:99], v133 offset:1024
    s_waitcnt lgkmcnt(11)
    v_mfma_f32_16x16x32_bf16 v[20:23], v[64:67], v[88:91], v[20:23]
    ds_read_b64_tr_b16 v[62:63], v130 offset:3360
    v_mfma_f32_16x16x32_bf16 v[16:19], v[64:67], v[84:87], v[16:19]
    ds_read_b64_tr_b16 v[64:65], v130 offset:64
    s_waitcnt lgkmcnt(11)
    v_mfma_f32_16x16x32_bf16 v[28:31], v[68:71], v[88:91], v[28:31]
    ds_read_b64_tr_b16 v[66:67], v130 offset:3392
    v_mfma_f32_16x16x32_bf16 v[24:27], v[68:71], v[84:87], v[24:27]
    ds_read_b64_tr_b16 v[68:69], v130 offset:96
    s_waitcnt lgkmcnt(11)
    v_mfma_f32_16x16x32_bf16 v[36:39], v[72:75], v[88:91], v[36:39]
    ds_read_b64_tr_b16 v[70:71], v130 offset:3424
    v_mfma_f32_16x16x32_bf16 v[32:35], v[72:75], v[84:87], v[32:35]
    ds_read_b64_tr_b16 v[72:73], v130 offset:128
    s_waitcnt lgkmcnt(11)
    v_mfma_f32_16x16x32_bf16 v[44:47], v[76:79], v[88:91], v[44:47]
    ds_read_b64_tr_b16 v[74:75], v130 offset:3456
    v_mfma_f32_16x16x32_bf16 v[40:43], v[76:79], v[84:87], v[40:43]
    ds_read_b64_tr_b16 v[76:77], v130 offset:160
    s_waitcnt vmcnt(12)
    s_barrier
    s_add_u32 m0, s56, 129024
    v_lshl_add_u32 v113, v113, 6, v136
    buffer_load_dwordx4 v113, s[8:11], 0 offen lds
    s_add_u32 s54, s54, 53248
    s_add_u32 m0, s57, 129024
    s_nop 0
    buffer_load_dwordx4 v129, s[12:15], s54 offen lds
    s_add_u32 m0, s55, 129024
    s_nop 0
    buffer_load_dwordx4 v128, s[12:15], s54 offen lds
    s_waitcnt lgkmcnt(8)
    v_mfma_f32_16x16x32_bf16 v[4:7], v[56:59], v[96:99], v[4:7]
    ds_read_b64_tr_b16 v[78:79], v130 offset:3488
    v_mfma_f32_16x16x32_bf16 v[0:3], v[56:59], v[92:95], v[0:3]
    ds_read_b64_tr_b16 v[56:57], v130 offset:21504
    s_waitcnt lgkmcnt(9)
    v_mfma_f32_16x16x32_bf16 v[12:15], v[60:63], v[96:99], v[12:15]
    ds_read_b64_tr_b16 v[58:59], v130 offset:24832
    v_mfma_f32_16x16x32_bf16 v[8:11], v[60:63], v[92:95], v[8:11]
    ds_read_b64_tr_b16 v[60:61], v130 offset:21536
    ds_read_b128 v[84:87], v133 offset:21504
    ds_read_b128 v[88:91], v133 offset:22528
    s_waitcnt lgkmcnt(11)
    v_mfma_f32_16x16x32_bf16 v[20:23], v[64:67], v[96:99], v[20:23]
    ds_read_b64_tr_b16 v[62:63], v130 offset:24864
    v_mfma_f32_16x16x32_bf16 v[16:19], v[64:67], v[92:95], v[16:19]
    ds_read_b64_tr_b16 v[64:65], v130 offset:21568
    s_waitcnt lgkmcnt(11)
    v_mfma_f32_16x16x32_bf16 v[28:31], v[68:71], v[96:99], v[28:31]
    ds_read_b64_tr_b16 v[66:67], v130 offset:24896
    v_mfma_f32_16x16x32_bf16 v[24:27], v[68:71], v[92:95], v[24:27]
    ds_read_b64_tr_b16 v[68:69], v130 offset:21600
    s_waitcnt lgkmcnt(11)
    v_mfma_f32_16x16x32_bf16 v[36:39], v[72:75], v[96:99], v[36:39]
    ds_read_b64_tr_b16 v[70:71], v130 offset:24928
    v_mfma_f32_16x16x32_bf16 v[32:35], v[72:75], v[92:95], v[32:35]
    ds_read_b64_tr_b16 v[72:73], v130 offset:21632
    s_waitcnt lgkmcnt(11)
    v_mfma_f32_16x16x32_bf16 v[44:47], v[76:79], v[96:99], v[44:47]
    ds_read_b64_tr_b16 v[74:75], v130 offset:24960
    v_mfma_f32_16x16x32_bf16 v[40:43], v[76:79], v[92:95], v[40:43]
    ds_read_b64_tr_b16 v[76:77], v130 offset:21664
    s_waitcnt vmcnt(12)
    s_barrier
    s_add_u32 m0, s56, 0
    v_lshl_add_u32 v114, v114, 6, v136
    buffer_load_dwordx4 v114, s[8:11], 0 offen lds
    s_add_u32 s54, s54, 53248
    s_add_u32 m0, s57, 0
    s_nop 0
    buffer_load_dwordx4 v129, s[12:15], s54 offen lds
    s_add_u32 m0, s55, 0
    s_nop 0
    buffer_load_dwordx4 v128, s[12:15], s54 offen lds
    s_waitcnt lgkmcnt(8)
    v_mfma_f32_16x16x32_bf16 v[4:7], v[56:59], v[88:91], v[4:7]
    ds_read_b64_tr_b16 v[78:79], v130 offset:24992
    v_mfma_f32_16x16x32_bf16 v[0:3], v[56:59], v[84:87], v[0:3]
    ds_read_b64_tr_b16 v[56:57], v130 offset:43008
    s_waitcnt lgkmcnt(9)
    v_mfma_f32_16x16x32_bf16 v[12:15], v[60:63], v[88:91], v[12:15]
    ds_read_b64_tr_b16 v[58:59], v130 offset:46336
    v_mfma_f32_16x16x32_bf16 v[8:11], v[60:63], v[84:87], v[8:11]
    ds_read_b64_tr_b16 v[60:61], v130 offset:43040
    ds_read_b128 v[92:95], v133 offset:43008
    ds_read_b128 v[96:99], v133 offset:44032
    s_waitcnt lgkmcnt(11)
    v_mfma_f32_16x16x32_bf16 v[20:23], v[64:67], v[88:91], v[20:23]
    ds_read_b64_tr_b16 v[62:63], v130 offset:46368
    v_mfma_f32_16x16x32_bf16 v[16:19], v[64:67], v[84:87], v[16:19]
    ds_read_b64_tr_b16 v[64:65], v130 offset:43072
    s_waitcnt lgkmcnt(11)
    v_mfma_f32_16x16x32_bf16 v[28:31], v[68:71], v[88:91], v[28:31]
    ds_read_b64_tr_b16 v[66:67], v130 offset:46400
    v_mfma_f32_16x16x32_bf16 v[24:27], v[68:71], v[84:87], v[24:27]
    ds_read_b64_tr_b16 v[68:69], v130 offset:43104
    s_waitcnt lgkmcnt(11)
    v_mfma_f32_16x16x32_bf16 v[36:39], v[72:75], v[88:91], v[36:39]
    ds_read_b64_tr_b16 v[70:71], v130 offset:46432
    v_mfma_f32_16x16x32_bf16 v[32:35], v[72:75], v[84:87], v[32:35]
    ds_read_b64_tr_b16 v[72:73], v130 offset:43136
    s_waitcnt lgkmcnt(11)
    v_mfma_f32_16x16x32_bf16 v[44:47], v[76:79], v[88:91], v[44:47]
    ds_read_b64_tr_b16 v[74:75], v130 offset:46464
    v_mfma_f32_16x16x32_bf16 v[40:43], v[76:79], v[84:87], v[40:43]
    ds_read_b64_tr_b16 v[76:77], v130 offset:43168
    s_waitcnt vmcnt(12)
    s_barrier
    s_add_u32 m0, s56, 21504
    v_lshl_add_u32 v115, v115, 6, v136
    buffer_load_dwordx4 v115, s[8:11], 0 offen lds
    s_add_u32 s54, s54, 53248
    s_add_u32 m0, s57, 21504
    s_nop 0
    buffer_load_dwordx4 v129, s[12:15], s54 offen lds
    s_add_u32 m0, s55, 21504
    s_nop 0
    buffer_load_dwordx4 v128, s[12:15], s54 offen lds
    s_waitcnt lgkmcnt(8)
    v_mfma_f32_16x16x32_bf16 v[4:7], v[56:59], v[96:99], v[4:7]
    ds_read_b64_tr_b16 v[78:79], v130 offset:46496
    v_mfma_f32_16x16x32_bf16 v[0:3], v[56:59], v[92:95], v[0:3]
    ds_read_b64_tr_b16 v[56:57], v131 offset:0
    s_waitcnt lgkmcnt(9)
    v_mfma_f32_16x16x32_bf16 v[12:15], v[60:63], v[96:99], v[12:15]
    ds_read_b64_tr_b16 v[58:59], v131 offset:3328
    v_mfma_f32_16x16x32_bf16 v[8:11], v[60:63], v[92:95], v[8:11]
    ds_read_b64_tr_b16 v[60:61], v131 offset:32
    ds_read_b128 v[84:87], v134 offset:0
    ds_read_b128 v[88:91], v134 offset:1024
    s_waitcnt lgkmcnt(11)
    v_mfma_f32_16x16x32_bf16 v[20:23], v[64:67], v[96:99], v[20:23]
    ds_read_b64_tr_b16 v[62:63], v131 offset:3360
    v_mfma_f32_16x16x32_bf16 v[16:19], v[64:67], v[92:95], v[16:19]
    ds_read_b64_tr_b16 v[64:65], v131 offset:64
    s_waitcnt lgkmcnt(11)
    v_mfma_f32_16x16x32_bf16 v[28:31], v[68:71], v[96:99], v[28:31]
    ds_read_b64_tr_b16 v[66:67], v131 offset:3392
    v_mfma_f32_16x16x32_bf16 v[24:27], v[68:71], v[92:95], v[24:27]
    ds_read_b64_tr_b16 v[68:69], v131 offset:96
    s_waitcnt lgkmcnt(11)
    v_mfma_f32_16x16x32_bf16 v[36:39], v[72:75], v[96:99], v[36:39]
    ds_read_b64_tr_b16 v[70:71], v131 offset:3424
    v_mfma_f32_16x16x32_bf16 v[32:35], v[72:75], v[92:95], v[32:35]
    ds_read_b64_tr_b16 v[72:73], v131 offset:128
    s_waitcnt lgkmcnt(11)
    v_mfma_f32_16x16x32_bf16 v[44:47], v[76:79], v[96:99], v[44:47]
    ds_read_b64_tr_b16 v[74:75], v131 offset:3456
    v_mfma_f32_16x16x32_bf16 v[40:43], v[76:79], v[92:95], v[40:43]
    ds_read_b64_tr_b16 v[76:77], v131 offset:160
    s_waitcnt vmcnt(12)
    s_barrier
    s_add_u32 m0, s56, 43008
    v_lshl_add_u32 v116, v116, 6, v136
    buffer_load_dwordx4 v116, s[8:11], 0 offen lds
    s_add_u32 s54, s54, 53248
    s_add_u32 m0, s57, 43008
    s_nop 0
    buffer_load_dwordx4 v129, s[12:15], s54 offen lds
    s_add_u32 m0, s55, 43008
    s_nop 0
    buffer_load_dwordx4 v128, s[12:15], s54 offen lds
    s_waitcnt lgkmcnt(8)
    v_mfma_f32_16x16x32_bf16 v[4:7], v[56:59], v[88:91], v[4:7]
    ds_read_b64_tr_b16 v[78:79], v131 offset:3488
    v_mfma_f32_16x16x32_bf16 v[0:3], v[56:59], v[84:87], v[0:3]
    ds_read_b64_tr_b16 v[56:57], v131 offset:21504
    s_waitcnt lgkmcnt(9)
    v_mfma_f32_16x16x32_bf16 v[12:15], v[60:63], v[88:91], v[12:15]
    ds_read_b64_tr_b16 v[58:59], v131 offset:24832
    v_mfma_f32_16x16x32_bf16 v[8:11], v[60:63], v[84:87], v[8:11]
    ds_read_b64_tr_b16 v[60:61], v131 offset:21536
    ds_read_b128 v[92:95], v134 offset:21504
    ds_read_b128 v[96:99], v134 offset:22528
    s_waitcnt lgkmcnt(11)
    v_mfma_f32_16x16x32_bf16 v[20:23], v[64:67], v[88:91], v[20:23]
    ds_read_b64_tr_b16 v[62:63], v131 offset:24864
    v_mfma_f32_16x16x32_bf16 v[16:19], v[64:67], v[84:87], v[16:19]
    ds_read_b64_tr_b16 v[64:65], v131 offset:21568
    s_waitcnt lgkmcnt(11)
    v_mfma_f32_16x16x32_bf16 v[28:31], v[68:71], v[88:91], v[28:31]
    ds_read_b64_tr_b16 v[66:67], v131 offset:24896
    v_mfma_f32_16x16x32_bf16 v[24:27], v[68:71], v[84:87], v[24:27]
    ds_read_b64_tr_b16 v[68:69], v131 offset:21600
    s_waitcnt lgkmcnt(11)
    v_mfma_f32_16x16x32_bf16 v[36:39], v[72:75], v[88:91], v[36:39]
    ds_read_b64_tr_b16 v[70:71], v131 offset:24928
    v_mfma_f32_16x16x32_bf16 v[32:35], v[72:75], v[84:87], v[32:35]
    ds_read_b64_tr_b16 v[72:73], v131 offset:21632
    s_waitcnt lgkmcnt(11)
    v_mfma_f32_16x16x32_bf16 v[44:47], v[76:79], v[88:91], v[44:47]
    ds_read_b64_tr_b16 v[74:75], v131 offset:24960
    v_mfma_f32_16x16x32_bf16 v[40:43], v[76:79], v[84:87], v[40:43]
    ds_read_b64_tr_b16 v[76:77], v131 offset:21664
    s_waitcnt vmcnt(12)
    s_barrier
    s_add_u32 m0, s56, 64512
    v_lshl_add_u32 v117, v117, 6, v136
    buffer_load_dwordx4 v117, s[8:11], 0 offen lds
    s_add_u32 s54, s54, 53248
    s_add_u32 m0, s57, 64512
    s_nop 0
    buffer_load_dwordx4 v129, s[12:15], s54 offen lds
    s_add_u32 m0, s55, 64512
    s_nop 0
    buffer_load_dwordx4 v128, s[12:15], s54 offen lds
    s_waitcnt lgkmcnt(8)
    v_mfma_f32_16x16x32_bf16 v[4:7], v[56:59], v[96:99], v[4:7]
    ds_read_b64_tr_b16 v[78:79], v131 offset:24992
    v_mfma_f32_16x16x32_bf16 v[0:3], v[56:59], v[92:95], v[0:3]
    ds_read_b64_tr_b16 v[56:57], v131 offset:43008
    s_waitcnt lgkmcnt(9)
    v_mfma_f32_16x16x32_bf16 v[12:15], v[60:63], v[96:99], v[12:15]
    ds_read_b64_tr_b16 v[58:59], v131 offset:46336
    v_mfma_f32_16x16x32_bf16 v[8:11], v[60:63], v[92:95], v[8:11]
    ds_read_b64_tr_b16 v[60:61], v131 offset:43040
    ds_read_b128 v[84:87], v134 offset:43008
    ds_read_b128 v[88:91], v134 offset:44032
    s_waitcnt lgkmcnt(11)
    v_mfma_f32_16x16x32_bf16 v[20:23], v[64:67], v[96:99], v[20:23]
    ds_read_b64_tr_b16 v[62:63], v131 offset:46368
    v_mfma_f32_16x16x32_bf16 v[16:19], v[64:67], v[92:95], v[16:19]
    ds_read_b64_tr_b16 v[64:65], v131 offset:43072
    s_waitcnt lgkmcnt(11)
    v_mfma_f32_16x16x32_bf16 v[28:31], v[68:71], v[96:99], v[28:31]
    ds_read_b64_tr_b16 v[66:67], v131 offset:46400
    v_mfma_f32_16x16x32_bf16 v[24:27], v[68:71], v[92:95], v[24:27]
    ds_read_b64_tr_b16 v[68:69], v131 offset:43104
    s_waitcnt lgkmcnt(11)
    v_mfma_f32_16x16x32_bf16 v[36:39], v[72:75], v[96:99], v[36:39]
    ds_read_b64_tr_b16 v[70:71], v131 offset:46432
    v_mfma_f32_16x16x32_bf16 v[32:35], v[72:75], v[92:95], v[32:35]
    ds_read_b64_tr_b16 v[72:73], v131 offset:43136
    s_waitcnt lgkmcnt(11)
    v_mfma_f32_16x16x32_bf16 v[44:47], v[76:79], v[96:99], v[44:47]
    ds_read_b64_tr_b16 v[74:75], v131 offset:46464
    v_mfma_f32_16x16x32_bf16 v[40:43], v[76:79], v[92:95], v[40:43]
    ds_read_b64_tr_b16 v[76:77], v131 offset:43168
    s_waitcnt vmcnt(12)
    s_barrier
    s_add_u32 m0, s56, 86016
    v_lshl_add_u32 v118, v118, 6, v136
    buffer_load_dwordx4 v118, s[8:11], 0 offen lds
    s_add_u32 s54, s54, 53248
    s_add_u32 m0, s57, 86016
    s_nop 0
    buffer_load_dwordx4 v129, s[12:15], s54 offen lds
    s_add_u32 m0, s55, 86016
    s_nop 0
    buffer_load_dwordx4 v128, s[12:15], s54 offen lds
    s_waitcnt lgkmcnt(8)
    v_mfma_f32_16x16x32_bf16 v[4:7], v[56:59], v[88:91], v[4:7]
    ds_read_b64_tr_b16 v[78:79], v131 offset:46496
    v_mfma_f32_16x16x32_bf16 v[0:3], v[56:59], v[84:87], v[0:3]
    ds_read_b64_tr_b16 v[56:57], v132 offset:0
    s_waitcnt lgkmcnt(9)
    v_mfma_f32_16x16x32_bf16 v[12:15], v[60:63], v[88:91], v[12:15]
    ds_read_b64_tr_b16 v[58:59], v132 offset:3328
    v_mfma_f32_16x16x32_bf16 v[8:11], v[60:63], v[84:87], v[8:11]
    ds_read_b64_tr_b16 v[60:61], v132 offset:32
    ds_read_b128 v[92:95], v135 offset:0
    ds_read_b128 v[96:99], v135 offset:1024
    s_waitcnt lgkmcnt(11)
    v_mfma_f32_16x16x32_bf16 v[20:23], v[64:67], v[88:91], v[20:23]
    ds_read_b64_tr_b16 v[62:63], v132 offset:3360
    v_mfma_f32_16x16x32_bf16 v[16:19], v[64:67], v[84:87], v[16:19]
    ds_read_b64_tr_b16 v[64:65], v132 offset:64
    s_waitcnt lgkmcnt(11)
    v_mfma_f32_16x16x32_bf16 v[28:31], v[68:71], v[88:91], v[28:31]
    ds_read_b64_tr_b16 v[66:67], v132 offset:3392
    v_mfma_f32_16x16x32_bf16 v[24:27], v[68:71], v[84:87], v[24:27]
    ds_read_b64_tr_b16 v[68:69], v132 offset:96
    s_waitcnt lgkmcnt(11)
    v_mfma_f32_16x16x32_bf16 v[36:39], v[72:75], v[88:91], v[36:39]
    ds_read_b64_tr_b16 v[70:71], v132 offset:3424
    v_mfma_f32_16x16x32_bf16 v[32:35], v[72:75], v[84:87], v[32:35]
    ds_read_b64_tr_b16 v[72:73], v132 offset:128
    s_waitcnt lgkmcnt(11)
    v_mfma_f32_16x16x32_bf16 v[44:47], v[76:79], v[88:91], v[44:47]
    ds_read_b64_tr_b16 v[74:75], v132 offset:3456
    v_mfma_f32_16x16x32_bf16 v[40:43], v[76:79], v[84:87], v[40:43]
    ds_read_b64_tr_b16 v[76:77], v132 offset:160
    s_waitcnt vmcnt(12)
    s_barrier
    s_add_u32 m0, s56, 107520
    v_lshl_add_u32 v119, v119, 6, v136
    buffer_load_dwordx4 v119, s[8:11], 0 offen lds
    s_add_u32 s54, s54, 53248
    s_add_u32 m0, s57, 107520
    s_nop 0
    buffer_load_dwordx4 v129, s[12:15], s54 offen lds
    s_add_u32 m0, s55, 107520
    s_nop 0
    buffer_load_dwordx4 v128, s[12:15], s54 offen lds
    s_waitcnt lgkmcnt(8)
    v_mfma_f32_16x16x32_bf16 v[4:7], v[56:59], v[96:99], v[4:7]
    ds_read_b64_tr_b16 v[78:79], v132 offset:3488
    v_mfma_f32_16x16x32_bf16 v[0:3], v[56:59], v[92:95], v[0:3]
    ds_read_b64_tr_b16 v[56:57], v130 offset:0
    s_waitcnt lgkmcnt(9)
    v_mfma_f32_16x16x32_bf16 v[12:15], v[60:63], v[96:99], v[12:15]
    ds_read_b64_tr_b16 v[58:59], v130 offset:3328
    v_mfma_f32_16x16x32_bf16 v[8:11], v[60:63], v[92:95], v[8:11]
    ds_read_b64_tr_b16 v[60:61], v130 offset:32
    ds_read_b128 v[84:87], v133 offset:0
    ds_read_b128 v[88:91], v133 offset:1024
    s_waitcnt lgkmcnt(11)
    v_mfma_f32_16x16x32_bf16 v[20:23], v[64:67], v[96:99], v[20:23]
    ds_read_b64_tr_b16 v[62:63], v130 offset:3360
    v_mfma_f32_16x16x32_bf16 v[16:19], v[64:67], v[92:95], v[16:19]
    ds_read_b64_tr_b16 v[64:65], v130 offset:64
    s_waitcnt lgkmcnt(11)
    v_mfma_f32_16x16x32_bf16 v[28:31], v[68:71], v[96:99], v[28:31]
    ds_read_b64_tr_b16 v[66:67], v130 offset:3392
    v_mfma_f32_16x16x32_bf16 v[24:27], v[68:71], v[92:95], v[24:27]
    ds_read_b64_tr_b16 v[68:69], v130 offset:96
    s_waitcnt lgkmcnt(11)
    v_mfma_f32_16x16x32_bf16 v[36:39], v[72:75], v[96:99], v[36:39]
    ds_read_b64_tr_b16 v[70:71], v130 offset:3424
    v_mfma_f32_16x16x32_bf16 v[32:35], v[72:75], v[92:95], v[32:35]
    ds_read_b64_tr_b16 v[72:73], v130 offset:128
    s_waitcnt lgkmcnt(11)
    v_mfma_f32_16x16x32_bf16 v[44:47], v[76:79], v[96:99], v[44:47]
    ds_read_b64_tr_b16 v[74:75], v130 offset:3456
    v_mfma_f32_16x16x32_bf16 v[40:43], v[76:79], v[92:95], v[40:43]
    ds_read_b64_tr_b16 v[76:77], v130 offset:160
    s_waitcnt vmcnt(12)
    s_barrier
    s_add_u32 m0, s56, 129024
    v_lshl_add_u32 v120, v120, 6, v136
    buffer_load_dwordx4 v120, s[8:11], 0 offen lds
    s_add_u32 s54, s54, 53248
    s_add_u32 m0, s57, 129024
    s_nop 0
    buffer_load_dwordx4 v129, s[12:15], s54 offen lds
    s_add_u32 m0, s55, 129024
    s_nop 0
    buffer_load_dwordx4 v128, s[12:15], s54 offen lds
    s_waitcnt lgkmcnt(8)
    v_mfma_f32_16x16x32_bf16 v[4:7], v[56:59], v[88:91], v[4:7]
    ds_read_b64_tr_b16 v[78:79], v130 offset:3488
    v_mfma_f32_16x16x32_bf16 v[0:3], v[56:59], v[84:87], v[0:3]
    ds_read_b64_tr_b16 v[56:57], v130 offset:21504
    s_waitcnt lgkmcnt(9)
    v_mfma_f32_16x16x32_bf16 v[12:15], v[60:63], v[88:91], v[12:15]
    ds_read_b64_tr_b16 v[58:59], v130 offset:24832
    v_mfma_f32_16x16x32_bf16 v[8:11], v[60:63], v[84:87], v[8:11]
    ds_read_b64_tr_b16 v[60:61], v130 offset:21536
    ds_read_b128 v[92:95], v133 offset:21504
    ds_read_b128 v[96:99], v133 offset:22528
    s_waitcnt lgkmcnt(11)
    v_mfma_f32_16x16x32_bf16 v[20:23], v[64:67], v[88:91], v[20:23]
    ds_read_b64_tr_b16 v[62:63], v130 offset:24864
    v_mfma_f32_16x16x32_bf16 v[16:19], v[64:67], v[84:87], v[16:19]
    ds_read_b64_tr_b16 v[64:65], v130 offset:21568
    s_waitcnt lgkmcnt(11)
    v_mfma_f32_16x16x32_bf16 v[28:31], v[68:71], v[88:91], v[28:31]
    ds_read_b64_tr_b16 v[66:67], v130 offset:24896
    v_mfma_f32_16x16x32_bf16 v[24:27], v[68:71], v[84:87], v[24:27]
    ds_read_b64_tr_b16 v[68:69], v130 offset:21600
    s_waitcnt lgkmcnt(11)
    v_mfma_f32_16x16x32_bf16 v[36:39], v[72:75], v[88:91], v[36:39]
    ds_read_b64_tr_b16 v[70:71], v130 offset:24928
    v_mfma_f32_16x16x32_bf16 v[32:35], v[72:75], v[84:87], v[32:35]
    ds_read_b64_tr_b16 v[72:73], v130 offset:21632
    s_waitcnt lgkmcnt(11)
    v_mfma_f32_16x16x32_bf16 v[44:47], v[76:79], v[88:91], v[44:47]
    ds_read_b64_tr_b16 v[74:75], v130 offset:24960
    v_mfma_f32_16x16x32_bf16 v[40:43], v[76:79], v[84:87], v[40:43]
    ds_read_b64_tr_b16 v[76:77], v130 offset:21664
    s_waitcnt vmcnt(12)
    s_barrier
    s_add_u32 m0, s56, 0
    v_lshl_add_u32 v121, v121, 6, v136
    buffer_load_dwordx4 v121, s[8:11], 0 offen lds
    s_add_u32 s54, s54, 53248
    s_add_u32 m0, s57, 0
    s_nop 0
    buffer_load_dwordx4 v129, s[12:15], s54 offen lds
    s_add_u32 m0, s55, 0
    s_nop 0
    buffer_load_dwordx4 v128, s[12:15], s54 offen lds
    s_waitcnt lgkmcnt(8)
    v_mfma_f32_16x16x32_bf16 v[4:7], v[56:59], v[96:99], v[4:7]
    ds_read_b64_tr_b16 v[78:79], v130 offset:24992
    v_mfma_f32_16x16x32_bf16 v[0:3], v[56:59], v[92:95], v[0:3]
    ds_read_b64_tr_b16 v[56:57], v130 offset:43008
    s_waitcnt lgkmcnt(9)
    v_mfma_f32_16x16x32_bf16 v[12:15], v[60:63], v[96:99], v[12:15]
    ds_read_b64_tr_b16 v[58:59], v130 offset:46336
    v_mfma_f32_16x16x32_bf16 v[8:11], v[60:63], v[92:95], v[8:11]
    ds_read_b64_tr_b16 v[60:61], v130 offset:43040
    ds_read_b128 v[84:87], v133 offset:43008
    ds_read_b128 v[88:91], v133 offset:44032
    s_waitcnt lgkmcnt(11)
    v_mfma_f32_16x16x32_bf16 v[20:23], v[64:67], v[96:99], v[20:23]
    ds_read_b64_tr_b16 v[62:63], v130 offset:46368
    v_mfma_f32_16x16x32_bf16 v[16:19], v[64:67], v[92:95], v[16:19]
    ds_read_b64_tr_b16 v[64:65], v130 offset:43072
    s_waitcnt lgkmcnt(11)
    v_mfma_f32_16x16x32_bf16 v[28:31], v[68:71], v[96:99], v[28:31]
    ds_read_b64_tr_b16 v[66:67], v130 offset:46400
    v_mfma_f32_16x16x32_bf16 v[24:27], v[68:71], v[92:95], v[24:27]
    ds_read_b64_tr_b16 v[68:69], v130 offset:43104
    s_waitcnt lgkmcnt(11)
    v_mfma_f32_16x16x32_bf16 v[36:39], v[72:75], v[96:99], v[36:39]
    ds_read_b64_tr_b16 v[70:71], v130 offset:46432
    v_mfma_f32_16x16x32_bf16 v[32:35], v[72:75], v[92:95], v[32:35]
    ds_read_b64_tr_b16 v[72:73], v130 offset:43136
    s_waitcnt lgkmcnt(11)
    v_mfma_f32_16x16x32_bf16 v[44:47], v[76:79], v[96:99], v[44:47]
    ds_read_b64_tr_b16 v[74:75], v130 offset:46464
    v_mfma_f32_16x16x32_bf16 v[40:43], v[76:79], v[92:95], v[40:43]
    ds_read_b64_tr_b16 v[76:77], v130 offset:43168
    s_waitcnt vmcnt(12)
    s_barrier
    s_add_u32 m0, s56, 21504
    v_lshl_add_u32 v122, v122, 6, v136
    buffer_load_dwordx4 v122, s[8:11], 0 offen lds
    s_add_u32 s54, s54, 53248
    s_add_u32 m0, s57, 21504
    s_nop 0
    buffer_load_dwordx4 v129, s[12:15], s54 offen lds
    s_add_u32 m0, s55, 21504
    s_nop 0
    buffer_load_dwordx4 v128, s[12:15], s54 offen lds
    s_waitcnt lgkmcnt(8)
    v_mfma_f32_16x16x32_bf16 v[4:7], v[56:59], v[88:91], v[4:7]
    ds_read_b64_tr_b16 v[78:79], v130 offset:46496
    v_mfma_f32_16x16x32_bf16 v[0:3], v[56:59], v[84:87], v[0:3]
    ds_read_b64_tr_b16 v[56:57], v131 offset:0
    s_waitcnt lgkmcnt(9)
    v_mfma_f32_16x16x32_bf16 v[12:15], v[60:63], v[88:91], v[12:15]
    ds_read_b64_tr_b16 v[58:59], v131 offset:3328
    v_mfma_f32_16x16x32_bf16 v[8:11], v[60:63], v[84:87], v[8:11]
    ds_read_b64_tr_b16 v[60:61], v131 offset:32
    ds_read_b128 v[92:95], v134 offset:0
    ds_read_b128 v[96:99], v134 offset:1024
    s_waitcnt lgkmcnt(11)
    v_mfma_f32_16x16x32_bf16 v[20:23], v[64:67], v[88:91], v[20:23]
    ds_read_b64_tr_b16 v[62:63], v131 offset:3360
    v_mfma_f32_16x16x32_bf16 v[16:19], v[64:67], v[84:87], v[16:19]
    ds_read_b64_tr_b16 v[64:65], v131 offset:64
    s_waitcnt lgkmcnt(11)
    v_mfma_f32_16x16x32_bf16 v[28:31], v[68:71], v[88:91], v[28:31]
    ds_read_b64_tr_b16 v[66:67], v131 offset:3392
    v_mfma_f32_16x16x32_bf16 v[24:27], v[68:71], v[84:87], v[24:27]
    ds_read_b64_tr_b16 v[68:69], v131 offset:96
    s_waitcnt lgkmcnt(11)
    v_mfma_f32_16x16x32_bf16 v[36:39], v[72:75], v[88:91], v[36:39]
    ds_read_b64_tr_b16 v[70:71], v131 offset:3424
    v_mfma_f32_16x16x32_bf16 v[32:35], v[72:75], v[84:87], v[32:35]
    ds_read_b64_tr_b16 v[72:73], v131 offset:128
    s_waitcnt lgkmcnt(11)
    v_mfma_f32_16x16x32_bf16 v[44:47], v[76:79], v[88:91], v[44:47]
    ds_read_b64_tr_b16 v[74:75], v131 offset:3456
    v_mfma_f32_16x16x32_bf16 v[40:43], v[76:79], v[84:87], v[40:43]
    ds_read_b64_tr_b16 v[76:77], v131 offset:160
    s_waitcnt vmcnt(12)
    s_barrier
    s_add_u32 m0, s56, 43008
    v_lshl_add_u32 v123, v123, 6, v136
    buffer_load_dwordx4 v123, s[8:11], 0 offen lds
    s_add_u32 s54, s54, 53248
    s_add_u32 m0, s57, 43008
    s_nop 0
    buffer_load_dwordx4 v129, s[12:15], s54 offen lds
    s_add_u32 m0, s55, 43008
    s_nop 0
    buffer_load_dwordx4 v128, s[12:15], s54 offen lds
    s_waitcnt lgkmcnt(8)
    v_mfma_f32_16x16x32_bf16 v[4:7], v[56:59], v[96:99], v[4:7]
    ds_read_b64_tr_b16 v[78:79], v131 offset:3488
    v_mfma_f32_16x16x32_bf16 v[0:3], v[56:59], v[92:95], v[0:3]
    ds_read_b64_tr_b16 v[56:57], v131 offset:21504
    s_waitcnt lgkmcnt(9)
    v_mfma_f32_16x16x32_bf16 v[12:15], v[60:63], v[96:99], v[12:15]
    ds_read_b64_tr_b16 v[58:59], v131 offset:24832
    v_mfma_f32_16x16x32_bf16 v[8:11], v[60:63], v[92:95], v[8:11]
    ds_read_b64_tr_b16 v[60:61], v131 offset:21536
    ds_read_b128 v[84:87], v134 offset:21504
    ds_read_b128 v[88:91], v134 offset:22528
    s_waitcnt lgkmcnt(11)
    v_mfma_f32_16x16x32_bf16 v[20:23], v[64:67], v[96:99], v[20:23]
    ds_read_b64_tr_b16 v[62:63], v131 offset:24864
    v_mfma_f32_16x16x32_bf16 v[16:19], v[64:67], v[92:95], v[16:19]
    ds_read_b64_tr_b16 v[64:65], v131 offset:21568
    s_waitcnt lgkmcnt(11)
    v_mfma_f32_16x16x32_bf16 v[28:31], v[68:71], v[96:99], v[28:31]
    ds_read_b64_tr_b16 v[66:67], v131 offset:24896
    v_mfma_f32_16x16x32_bf16 v[24:27], v[68:71], v[92:95], v[24:27]
    ds_read_b64_tr_b16 v[68:69], v131 offset:21600
    s_waitcnt lgkmcnt(11)
    v_mfma_f32_16x16x32_bf16 v[36:39], v[72:75], v[96:99], v[36:39]
    ds_read_b64_tr_b16 v[70:71], v131 offset:24928
    v_mfma_f32_16x16x32_bf16 v[32:35], v[72:75], v[92:95], v[32:35]
    ds_read_b64_tr_b16 v[72:73], v131 offset:21632
    s_waitcnt lgkmcnt(11)
    v_mfma_f32_16x16x32_bf16 v[44:47], v[76:79], v[96:99], v[44:47]
    ds_read_b64_tr_b16 v[74:75], v131 offset:24960
    v_mfma_f32_16x16x32_bf16 v[40:43], v[76:79], v[92:95], v[40:43]
    ds_read_b64_tr_b16 v[76:77], v131 offset:21664
    s_waitcnt vmcnt(12)
    s_barrier
    s_add_u32 m0, s56, 64512
    v_lshl_add_u32 v124, v124, 6, v136
    buffer_load_dwordx4 v124, s[8:11], 0 offen lds
    s_add_u32 s54, s54, 53248
    s_add_u32 m0, s57, 64512
    s_nop 0
    buffer_load_dwordx4 v129, s[12:15], s54 offen lds
    s_add_u32 m0, s55, 64512
    s_nop 0
    buffer_load_dwordx4 v128, s[12:15], s54 offen lds
    s_waitcnt lgkmcnt(8)
    v_mfma_f32_16x16x32_bf16 v[4:7], v[56:59], v[88:91], v[4:7]
    ds_read_b64_tr_b16 v[78:79], v131 offset:24992
    v_mfma_f32_16x16x32_bf16 v[0:3], v[56:59], v[84:87], v[0:3]
    ds_read_b64_tr_b16 v[56:57], v131 offset:43008
    s_waitcnt lgkmcnt(9)
    v_mfma_f32_16x16x32_bf16 v[12:15], v[60:63], v[88:91], v[12:15]
    ds_read_b64_tr_b16 v[58:59], v131 offset:46336
    v_mfma_f32_16x16x32_bf16 v[8:11], v[60:63], v[84:87], v[8:11]
    ds_read_b64_tr_b16 v[60:61], v131 offset:43040
    ds_read_b128 v[92:95], v134 offset:43008
    ds_read_b128 v[96:99], v134 offset:44032
    s_waitcnt lgkmcnt(11)
    v_mfma_f32_16x16x32_bf16 v[20:23], v[64:67], v[88:91], v[20:23]
    ds_read_b64_tr_b16 v[62:63], v131 offset:46368
    v_mfma_f32_16x16x32_bf16 v[16:19], v[64:67], v[84:87], v[16:19]
    ds_read_b64_tr_b16 v[64:65], v131 offset:43072
    s_waitcnt lgkmcnt(11)
    v_mfma_f32_16x16x32_bf16 v[28:31], v[68:71], v[88:91], v[28:31]
    ds_read_b64_tr_b16 v[66:67], v131 offset:46400
    v_mfma_f32_16x16x32_bf16 v[24:27], v[68:71], v[84:87], v[24:27]
    ds_read_b64_tr_b16 v[68:69], v131 offset:43104
    s_waitcnt lgkmcnt(11)
    v_mfma_f32_16x16x32_bf16 v[36:39], v[72:75], v[88:91], v[36:39]
    ds_read_b64_tr_b16 v[70:71], v131 offset:46432
    v_mfma_f32_16x16x32_bf16 v[32:35], v[72:75], v[84:87], v[32:35]
    ds_read_b64_tr_b16 v[72:73], v131 offset:43136
    s_waitcnt lgkmcnt(11)
    v_mfma_f32_16x16x32_bf16 v[44:47], v[76:79], v[88:91], v[44:47]
    ds_read_b64_tr_b16 v[74:75], v131 offset:46464
    v_mfma_f32_16x16x32_bf16 v[40:43], v[76:79], v[84:87], v[40:43]
    ds_read_b64_tr_b16 v[76:77], v131 offset:43168
    s_waitcnt vmcnt(12)
    s_barrier
    s_add_u32 m0, s56, 86016
    v_lshl_add_u32 v125, v125, 6, v136
    buffer_load_dwordx4 v125, s[8:11], 0 offen lds
    s_add_u32 s54, s54, 53248
    s_add_u32 m0, s57, 86016
    s_nop 0
    buffer_load_dwordx4 v129, s[12:15], s54 offen lds
    s_add_u32 m0, s55, 86016
    s_nop 0
    buffer_load_dwordx4 v128, s[12:15], s54 offen lds
    s_waitcnt lgkmcnt(8)
    v_mfma_f32_16x16x32_bf16 v[4:7], v[56:59], v[96:99], v[4:7]
    ds_read_b64_tr_b16 v[78:79], v131 offset:46496
    v_mfma_f32_16x16x32_bf16 v[0:3], v[56:59], v[92:95], v[0:3]
    ds_read_b64_tr_b16 v[56:57], v132 offset:0
    s_waitcnt lgkmcnt(9)
    v_mfma_f32_16x16x32_bf16 v[12:15], v[60:63], v[96:99], v[12:15]
    ds_read_b64_tr_b16 v[58:59], v132 offset:3328
    v_mfma_f32_16x16x32_bf16 v[8:11], v[60:63], v[92:95], v[8:11]
    ds_read_b64_tr_b16 v[60:61], v132 offset:32
    ds_read_b128 v[84:87], v135 offset:0
    ds_read_b128 v[88:91], v135 offset:1024
    s_waitcnt lgkmcnt(11)
    v_mfma_f32_16x16x32_bf16 v[20:23], v[64:67], v[96:99], v[20:23]
    ds_read_b64_tr_b16 v[62:63], v132 offset:3360
    v_mfma_f32_16x16x32_bf16 v[16:19], v[64:67], v[92:95], v[16:19]
    ds_read_b64_tr_b16 v[64:65], v132 offset:64
    s_waitcnt lgkmcnt(11)
    v_mfma_f32_16x16x32_bf16 v[28:31], v[68:71], v[96:99], v[28:31]
    ds_read_b64_tr_b16 v[66:67], v132 offset:3392
    v_mfma_f32_16x16x32_bf16 v[24:27], v[68:71], v[92:95], v[24:27]
    ds_read_b64_tr_b16 v[68:69], v132 offset:96
    s_waitcnt lgkmcnt(11)
    v_mfma_f32_16x16x32_bf16 v[36:39], v[72:75], v[96:99], v[36:39]
    ds_read_b64_tr_b16 v[70:71], v132 offset:3424
    v_mfma_f32_16x16x32_bf16 v[32:35], v[72:75], v[92:95], v[32:35]
    ds_read_b64_tr_b16 v[72:73], v132 offset:128
    s_waitcnt lgkmcnt(11)
    v_mfma_f32_16x16x32_bf16 v[44:47], v[76:79], v[96:99], v[44:47]
    ds_read_b64_tr_b16 v[74:75], v132 offset:3456
    v_mfma_f32_16x16x32_bf16 v[40:43], v[76:79], v[92:95], v[40:43]
    ds_read_b64_tr_b16 v[76:77], v132 offset:160
    s_waitcnt vmcnt(12)
    s_barrier
    s_waitcnt lgkmcnt(8)
    v_mfma_f32_16x16x32_bf16 v[4:7], v[56:59], v[88:91], v[4:7]
    ds_read_b64_tr_b16 v[78:79], v132 offset:3488
    v_mfma_f32_16x16x32_bf16 v[0:3], v[56:59], v[84:87], v[0:3]
    ds_read_b64_tr_b16 v[56:57], v130 offset:0
    s_waitcnt lgkmcnt(9)
    v_mfma_f32_16x16x32_bf16 v[12:15], v[60:63], v[88:91], v[12:15]
    ds_read_b64_tr_b16 v[58:59], v130 offset:3328
    v_mfma_f32_16x16x32_bf16 v[8:11], v[60:63], v[84:87], v[8:11]
    ds_read_b64_tr_b16 v[60:61], v130 offset:32
    ds_read_b128 v[92:95], v133 offset:0
    ds_read_b128 v[96:99], v133 offset:1024
    s_waitcnt lgkmcnt(11)
    v_mfma_f32_16x16x32_bf16 v[20:23], v[64:67], v[88:91], v[20:23]
    ds_read_b64_tr_b16 v[62:63], v130 offset:3360
    v_mfma_f32_16x16x32_bf16 v[16:19], v[64:67], v[84:87], v[16:19]
    ds_read_b64_tr_b16 v[64:65], v130 offset:64
    s_waitcnt lgkmcnt(11)
    v_mfma_f32_16x16x32_bf16 v[28:31], v[68:71], v[88:91], v[28:31]
    ds_read_b64_tr_b16 v[66:67], v130 offset:3392
    v_mfma_f32_16x16x32_bf16 v[24:27], v[68:71], v[84:87], v[24:27]
    ds_read_b64_tr_b16 v[68:69], v130 offset:96
    s_waitcnt lgkmcnt(11)
    v_mfma_f32_16x16x32_bf16 v[36:39], v[72:75], v[88:91], v[36:39]
    ds_read_b64_tr_b16 v[70:71], v130 offset:3424
    v_mfma_f32_16x16x32_bf16 v[32:35], v[72:75], v[84:87], v[32:35]
    ds_read_b64_tr_b16 v[72:73], v130 offset:128
    s_waitcnt lgkmcnt(11)
    v_mfma_f32_16x16x32_bf16 v[44:47], v[76:79], v[88:91], v[44:47]
    ds_read_b64_tr_b16 v[74:75], v130 offset:3456
    v_mfma_f32_16x16x32_bf16 v[40:43], v[76:79], v[84:87], v[40:43]
    ds_read_b64_tr_b16 v[76:77], v130 offset:160
    s_waitcnt vmcnt(9)
    s_barrier
    s_waitcnt lgkmcnt(8)
    v_mfma_f32_16x16x32_bf16 v[4:7], v[56:59], v[96:99], v[4:7]
    ds_read_b64_tr_b16 v[78:79], v130 offset:3488
    v_mfma_f32_16x16x32_bf16 v[0:3], v[56:59], v[92:95], v[0:3]
    ds_read_b64_tr_b16 v[56:57], v130 offset:21504
    ds_read_b64 v[200:201], v138 offset:1664
    s_waitcnt lgkmcnt(10)
    v_mfma_f32_16x16x32_bf16 v[12:15], v[60:63], v[96:99], v[12:15]
    ds_read_b64_tr_b16 v[58:59], v130 offset:24832
    v_mfma_f32_16x16x32_bf16 v[8:11], v[60:63], v[92:95], v[8:11]
    ds_read_b64_tr_b16 v[60:61], v130 offset:21536
    ds_read_b128 v[84:87], v133 offset:21504
    ds_read_b128 v[88:91], v133 offset:22528
    ds_read_b64 v[202:203], v138 offset:1696
    s_waitcnt lgkmcnt(13)
    v_mfma_f32_16x16x32_bf16 v[20:23], v[64:67], v[96:99], v[20:23]
    ds_read_b64_tr_b16 v[62:63], v130 offset:24864
    v_mfma_f32_16x16x32_bf16 v[16:19], v[64:67], v[92:95], v[16:19]
    ds_read_b64_tr_b16 v[64:65], v130 offset:21568
    ds_read_b64 v[204:205], v138 offset:1728
    s_waitcnt lgkmcnt(14)
    v_mfma_f32_16x16x32_bf16 v[28:31], v[68:71], v[96:99], v[28:31]
    ds_read_b64_tr_b16 v[66:67], v130 offset:24896
    v_mfma_f32_16x16x32_bf16 v[24:27], v[68:71], v[92:95], v[24:27]
    ds_read_b64_tr_b16 v[68:69], v130 offset:21600
    ds_read_b64 v[206:207], v138 offset:1760
    s_waitcnt lgkmcnt(15)
    v_mfma_f32_16x16x32_bf16 v[36:39], v[72:75], v[96:99], v[36:39]
    ds_read_b64_tr_b16 v[70:71], v130 offset:24928
    v_mfma_f32_16x16x32_bf16 v[32:35], v[72:75], v[92:95], v[32:35]
    ds_read_b64_tr_b16 v[72:73], v130 offset:21632
    ds_read_b64 v[208:209], v138 offset:1792
    s_waitcnt lgkmcnt(15)
    v_mfma_f32_16x16x32_bf16 v[44:47], v[76:79], v[96:99], v[44:47]
    ds_read_b64_tr_b16 v[74:75], v130 offset:24960
    v_mfma_f32_16x16x32_bf16 v[40:43], v[76:79], v[92:95], v[40:43]
    ds_read_b64_tr_b16 v[76:77], v130 offset:21664
    ds_read_b64 v[210:211], v138 offset:1824
    ds_read_b64 v[212:213], v138 offset:1856
    s_waitcnt vmcnt(0)
    s_barrier
    s_waitcnt lgkmcnt(14)
    v_mfma_f32_16x16x32_bf16 v[4:7], v[56:59], v[88:91], v[4:7]
    ds_read_b64_tr_b16 v[78:79], v130 offset:24992
    v_mfma_f32_16x16x32_bf16 v[0:3], v[56:59], v[84:87], v[0:3]
    ds_read_b64_tr_b16 v[56:57], v130 offset:43008
    s_waitcnt lgkmcnt(14)
    v_mfma_f32_16x16x32_bf16 v[12:15], v[60:63], v[88:91], v[12:15]
    ds_read_b64_tr_b16 v[58:59], v130 offset:46336
    v_mfma_f32_16x16x32_bf16 v[8:11], v[60:63], v[84:87], v[8:11]
    ds_read_b64_tr_b16 v[60:61], v130 offset:43040
    ds_read_b128 v[92:95], v133 offset:43008
    ds_read_b128 v[96:99], v133 offset:44032
    s_waitcnt lgkmcnt(15)
    v_mfma_f32_16x16x32_bf16 v[20:23], v[64:67], v[88:91], v[20:23]
    ds_read_b64_tr_b16 v[62:63], v130 offset:46368
    v_mfma_f32_16x16x32_bf16 v[16:19], v[64:67], v[84:87], v[16:19]
    ds_read_b64_tr_b16 v[64:65], v130 offset:43072
    s_waitcnt lgkmcnt(14)
    v_mfma_f32_16x16x32_bf16 v[28:31], v[68:71], v[88:91], v[28:31]
    ds_read_b64_tr_b16 v[66:67], v130 offset:46400
    v_mfma_f32_16x16x32_bf16 v[24:27], v[68:71], v[84:87], v[24:27]
    ds_read_b64_tr_b16 v[68:69], v130 offset:43104
    s_waitcnt lgkmcnt(13)
    v_mfma_f32_16x16x32_bf16 v[36:39], v[72:75], v[88:91], v[36:39]
    ds_read_b64_tr_b16 v[70:71], v130 offset:46432
    v_mfma_f32_16x16x32_bf16 v[32:35], v[72:75], v[84:87], v[32:35]
    ds_read_b64_tr_b16 v[72:73], v130 offset:43136
    s_waitcnt lgkmcnt(11)
    v_mfma_f32_16x16x32_bf16 v[44:47], v[76:79], v[88:91], v[44:47]
    ds_read_b64_tr_b16 v[74:75], v130 offset:46464
    v_mfma_f32_16x16x32_bf16 v[40:43], v[76:79], v[84:87], v[40:43]
    ds_read_b64_tr_b16 v[76:77], v130 offset:43168
    s_waitcnt lgkmcnt(8)
    v_mfma_f32_16x16x32_bf16 v[4:7], v[56:59], v[96:99], v[4:7]
    ds_read_b64_tr_b16 v[78:79], v130 offset:46496
    v_mfma_f32_16x16x32_bf16 v[0:3], v[56:59], v[92:95], v[0:3]
    ds_read_b64_tr_b16 v[56:57], v131 offset:0
    v_lshlrev_b32 v170, 16, v200
    v_and_b32 v171, 0xffff0000, v200
    v_lshlrev_b32 v172, 16, v201
    s_waitcnt lgkmcnt(9)
    v_mfma_f32_16x16x32_bf16 v[12:15], v[60:63], v[96:99], v[12:15]
    ds_read_b64_tr_b16 v[58:59], v131 offset:3328
    v_mfma_f32_16x16x32_bf16 v[8:11], v[60:63], v[92:95], v[8:11]
    ds_read_b64_tr_b16 v[60:61], v131 offset:32
    ds_read_b128 v[84:87], v134 offset:0
    ds_read_b128 v[88:91], v134 offset:1024
    v_and_b32 v173, 0xffff0000, v201
    v_lshlrev_b32 v174, 16, v202
    v_and_b32 v175, 0xffff0000, v202
    s_waitcnt lgkmcnt(11)
    v_mfma_f32_16x16x32_bf16 v[20:23], v[64:67], v[96:99], v[20:23]
    ds_read_b64_tr_b16 v[62:63], v131 offset:3360
    v_mfma_f32_16x16x32_bf16 v[16:19], v[64:67], v[92:95], v[16:19]
    ds_read_b64_tr_b16 v[64:65], v131 offset:64
    v_lshlrev_b32 v176, 16, v203
    v_and_b32 v177, 0xffff0000, v203
    v_lshlrev_b32 v178, 16, v204
    s_waitcnt lgkmcnt(11)
    v_mfma_f32_16x16x32_bf16 v[28:31], v[68:71], v[96:99], v[28:31]
    ds_read_b64_tr_b16 v[66:67], v131 offset:3392
    v_mfma_f32_16x16x32_bf16 v[24:27], v[68:71], v[92:95], v[24:27]
    ds_read_b64_tr_b16 v[68:69], v131 offset:96
    v_and_b32 v179, 0xffff0000, v204
    v_lshlrev_b32 v180, 16, v205
    v_and_b32 v181, 0xffff0000, v205
    s_waitcnt lgkmcnt(11)
    v_mfma_f32_16x16x32_bf16 v[36:39], v[72:75], v[96:99], v[36:39]
    ds_read_b64_tr_b16 v[70:71], v131 offset:3424
    v_mfma_f32_16x16x32_bf16 v[32:35], v[72:75], v[92:95], v[32:35]
    ds_read_b64_tr_b16 v[72:73], v131 offset:128
    v_lshlrev_b32 v182, 16, v206
    v_and_b32 v183, 0xffff0000, v206
    v_lshlrev_b32 v184, 16, v207
    s_waitcnt lgkmcnt(11)
    v_mfma_f32_16x16x32_bf16 v[44:47], v[76:79], v[96:99], v[44:47]
    ds_read_b64_tr_b16 v[74:75], v131 offset:3456
    v_mfma_f32_16x16x32_bf16 v[40:43], v[76:79], v[92:95], v[40:43]
    ds_read_b64_tr_b16 v[76:77], v131 offset:160
    v_and_b32 v185, 0xffff0000, v207
    v_lshlrev_b32 v186, 16, v208
    v_and_b32 v187, 0xffff0000, v208
    s_waitcnt lgkmcnt(8)
    v_mfma_f32_16x16x32_bf16 v[4:7], v[56:59], v[88:91], v[4:7]
    ds_read_b64_tr_b16 v[78:79], v131 offset:3488
    v_mfma_f32_16x16x32_bf16 v[0:3], v[56:59], v[84:87], v[0:3]
    ds_read_b64_tr_b16 v[56:57], v131 offset:21504
    v_lshlrev_b32 v188, 16, v209
    v_and_b32 v189, 0xffff0000, v209
    v_lshlrev_b32 v190, 16, v210
    s_waitcnt lgkmcnt(9)
    v_mfma_f32_16x16x32_bf16 v[12:15], v[60:63], v[88:91], v[12:15]
    ds_read_b64_tr_b16 v[58:59], v131 offset:24832
    v_mfma_f32_16x16x32_bf16 v[8:11], v[60:63], v[84:87], v[8:11]
    ds_read_b64_tr_b16 v[60:61], v131 offset:21536
    ds_read_b128 v[92:95], v134 offset:21504
    ds_read_b128 v[96:99], v134 offset:22528
    v_and_b32 v191, 0xffff0000, v210
    v_lshlrev_b32 v192, 16, v211
    v_and_b32 v193, 0xffff0000, v211
    s_waitcnt lgkmcnt(11)
    v_mfma_f32_16x16x32_bf16 v[20:23], v[64:67], v[88:91], v[20:23]
    ds_read_b64_tr_b16 v[62:63], v131 offset:24864
    v_mfma_f32_16x16x32_bf16 v[16:19], v[64:67], v[84:87], v[16:19]
    ds_read_b64_tr_b16 v[64:65], v131 offset:21568
    v_lshlrev_b32 v194, 16, v212
    v_and_b32 v195, 0xffff0000, v212
    v_lshlrev_b32 v196, 16, v213
    s_waitcnt lgkmcnt(11)
    v_mfma_f32_16x16x32_bf16 v[28:31], v[68:71], v[88:91], v[28:31]
    ds_read_b64_tr_b16 v[66:67], v131 offset:24896
    v_mfma_f32_16x16x32_bf16 v[24:27], v[68:71], v[84:87], v[24:27]
    ds_read_b64_tr_b16 v[68:69], v131 offset:21600
    v_and_b32 v197, 0xffff0000, v213
    s_waitcnt lgkmcnt(11)
    v_mfma_f32_16x16x32_bf16 v[36:39], v[72:75], v[88:91], v[36:39]
    ds_read_b64_tr_b16 v[70:71], v131 offset:24928
    v_mfma_f32_16x16x32_bf16 v[32:35], v[72:75], v[84:87], v[32:35]
    ds_read_b64_tr_b16 v[72:73], v131 offset:21632
    s_waitcnt lgkmcnt(11)
    v_mfma_f32_16x16x32_bf16 v[44:47], v[76:79], v[88:91], v[44:47]
    ds_read_b64_tr_b16 v[74:75], v131 offset:24960
    v_mfma_f32_16x16x32_bf16 v[40:43], v[76:79], v[84:87], v[40:43]
    ds_read_b64_tr_b16 v[76:77], v131 offset:21664
    s_waitcnt lgkmcnt(8)
    v_mfma_f32_16x16x32_bf16 v[4:7], v[56:59], v[96:99], v[4:7]
    ds_read_b64_tr_b16 v[78:79], v131 offset:24992
    v_mfma_f32_16x16x32_bf16 v[0:3], v[56:59], v[92:95], v[0:3]
    s_waitcnt lgkmcnt(8)
    v_mfma_f32_16x16x32_bf16 v[12:15], v[60:63], v[96:99], v[12:15]
    v_mfma_f32_16x16x32_bf16 v[8:11], v[60:63], v[92:95], v[8:11]
    s_waitcnt lgkmcnt(6)
    v_mfma_f32_16x16x32_bf16 v[20:23], v[64:67], v[96:99], v[20:23]
    v_mfma_f32_16x16x32_bf16 v[16:19], v[64:67], v[92:95], v[16:19]
    s_waitcnt lgkmcnt(4)
    v_mfma_f32_16x16x32_bf16 v[28:31], v[68:71], v[96:99], v[28:31]
    v_mfma_f32_16x16x32_bf16 v[24:27], v[68:71], v[92:95], v[24:27]
    s_waitcnt lgkmcnt(2)
    v_mfma_f32_16x16x32_bf16 v[36:39], v[72:75], v[96:99], v[36:39]
    v_mfma_f32_16x16x32_bf16 v[32:35], v[72:75], v[92:95], v[32:35]
    s_waitcnt lgkmcnt(0)
    v_mfma_f32_16x16x32_bf16 v[44:47], v[76:79], v[96:99], v[44:47]
    v_mfma_f32_16x16x32_bf16 v[40:43], v[76:79], v[92:95], v[40:43]
L_gelu:
    v_mov_b32 v98, 0
    global_load_dword v99, v98, s[38:39] offset:64 sc1
    v_mov_b32 v72, 0xbdd2d3e8
    v_mov_b32 v73, 0xbdd2d3e8
    v_mov_b32 v74, 0xc0135761
    v_mov_b32 v75, 0xc0135761
    v_mov_b32 v92, 0
    v_mov_b32 v93, 0
    v_mov_b32 v94, 0
    v_mov_b32 v95, 0
    v_pk_mul_f32 v[56:57], v[0:1], v[0:1]
    v_pk_mul_f32 v[58:59], v[2:3], v[2:3]
    v_pk_mul_f32 v[60:61], v[4:5], v[4:5]
    v_pk_mul_f32 v[62:63], v[6:7], v[6:7]
    v_pk_fma_f32 v[56:57], v[56:57], v[72:73], v[74:75]
    v_pk_fma_f32 v[58:59], v[58:59], v[72:73], v[74:75]
    v_pk_fma_f32 v[60:61], v[60:61], v[72:73], v[74:75]
    v_pk_fma_f32 v[62:63], v[62:63], v[72:73], v[74:75]
    v_pk_mul_f32 v[56:57], v[56:57], v[0:1]
    v_pk_mul_f32 v[58:59], v[58:59], v[2:3]
    v_pk_mul_f32 v[60:61], v[60:61], v[4:5]
    v_pk_mul_f32 v[62:63], v[62:63], v[6:7]
    v_exp_f32 v56, v56
    v_exp_f32 v57, v57
    v_exp_f32 v58, v58
    v_exp_f32 v59, v59
    v_exp_f32 v60, v60
    v_exp_f32 v61, v61
    v_exp_f32 v62, v62
    v_exp_f32 v63, v63
    v_pk_mul_f32 v[64:65], v[0:1], v[170:171]
    v_pk_mul_f32 v[66:67], v[2:3], v[172:173]
    v_pk_mul_f32 v[68:69], v[4:5], v[170:171]
    v_pk_mul_f32 v[70:71], v[6:7], v[172:173]
    v_pk_add_f32 v[56:57], v[56:57], 1.0 op_sel_hi:[1,0]
    v_pk_add_f32 v[58:59], v[58:59], 1.0 op_sel_hi:[1,0]
    v_pk_add_f32 v[60:61], v[60:61], 1.0 op_sel_hi:[1,0]
    v_pk_add_f32 v[62:63], v[62:63], 1.0 op_sel_hi:[1,0]
    v_rcp_f32 v56, v56
    v_rcp_f32 v57, v57
    v_rcp_f32 v58, v58
    v_rcp_f32 v59, v59
    v_rcp_f32 v60, v60
    v_rcp_f32 v61, v61
    v_rcp_f32 v62, v62
    v_rcp_f32 v63, v63
    v_pk_fma_f32 v[92:93], v[56:57], v[64:65], v[92:93]
    v_pk_fma_f32 v[94:95], v[60:61], v[68:69], v[94:95]
    v_pk_fma_f32 v[92:93], v[58:59], v[66:67], v[92:93]
    v_pk_fma_f32 v[94:95], v[62:63], v[70:71], v[94:95]
    v_pk_mul_f32 v[56:57], v[8:9], v[8:9]
    v_pk_mul_f32 v[58:59], v[10:11], v[10:11]
    v_pk_mul_f32 v[60:61], v[12:13], v[12:13]
    v_pk_mul_f32 v[62:63], v[14:15], v[14:15]
    v_pk_fma_f32 v[56:57], v[56:57], v[72:73], v[74:75]
    v_pk_fma_f32 v[58:59], v[58:59], v[72:73], v[74:75]
    v_pk_fma_f32 v[60:61], v[60:61], v[72:73], v[74:75]
    v_pk_fma_f32 v[62:63], v[62:63], v[72:73], v[74:75]
    v_pk_mul_f32 v[56:57], v[56:57], v[8:9]
    v_pk_mul_f32 v[58:59], v[58:59], v[10:11]
    v_pk_mul_f32 v[60:61], v[60:61], v[12:13]
    v_pk_mul_f32 v[62:63], v[62:63], v[14:15]
    v_exp_f32 v56, v56
    v_exp_f32 v57, v57
    v_exp_f32 v58, v58
    v_exp_f32 v59, v59
    v_exp_f32 v60, v60
    v_exp_f32 v61, v61
    v_exp_f32 v62, v62
    v_exp_f32 v63, v63
    v_pk_mul_f32 v[64:65], v[8:9], v[174:175]
    v_pk_mul_f32 v[66:67], v[10:11], v[176:177]
    v_pk_mul_f32 v[68:69], v[12:13], v[174:175]
    v_pk_mul_f32 v[70:71], v[14:15], v[176:177]
    v_pk_add_f32 v[56:57], v[56:57], 1.0 op_sel_hi:[1,0]
    v_pk_add_f32 v[58:59], v[58:59], 1.0 op_sel_hi:[1,0]
    v_pk_add_f32 v[60:61], v[60:61], 1.0 op_sel_hi:[1,0]
    v_pk_add_f32 v[62:63], v[62:63], 1.0 op_sel_hi:[1,0]
    v_rcp_f32 v56, v56
    v_rcp_f32 v57, v57
    v_rcp_f32 v58, v58
    v_rcp_f32 v59, v59
    v_rcp_f32 v60, v60
    v_rcp_f32 v61, v61
    v_rcp_f32 v62, v62
    v_rcp_f32 v63, v63
    v_pk_fma_f32 v[92:93], v[56:57], v[64:65], v[92:93]
    v_pk_fma_f32 v[94:95], v[60:61], v[68:69], v[94:95]
    v_pk_fma_f32 v[92:93], v[58:59], v[66:67], v[92:93]
    v_pk_fma_f32 v[94:95], v[62:63], v[70:71], v[94:95]
    v_pk_mul_f32 v[56:57], v[16:17], v[16:17]
    v_pk_mul_f32 v[58:59], v[18:19], v[18:19]
    v_pk_mul_f32 v[60:61], v[20:21], v[20:21]
    v_pk_mul_f32 v[62:63], v[22:23], v[22:23]
    v_pk_fma_f32 v[56:57], v[56:57], v[72:73], v[74:75]
    v_pk_fma_f32 v[58:59], v[58:59], v[72:73], v[74:75]
    v_pk_fma_f32 v[60:61], v[60:61], v[72:73], v[74:75]
    v_pk_fma_f32 v[62:63], v[62:63], v[72:73], v[74:75]
    v_pk_mul_f32 v[56:57], v[56:57], v[16:17]
    v_pk_mul_f32 v[58:59], v[58:59], v[18:19]
    v_pk_mul_f32 v[60:61], v[60:61], v[20:21]
    v_pk_mul_f32 v[62:63], v[62:63], v[22:23]
    v_exp_f32 v56, v56
    v_exp_f32 v57, v57
    v_exp_f32 v58, v58
    v_exp_f32 v59, v59
    v_exp_f32 v60, v60
    v_exp_f32 v61, v61
    v_exp_f32 v62, v62
    v_exp_f32 v63, v63
    v_pk_mul_f32 v[64:65], v[16:17], v[178:179]
    v_pk_mul_f32 v[66:67], v[18:19], v[180:181]
    v_pk_mul_f32 v[68:69], v[20:21], v[178:179]
    v_pk_mul_f32 v[70:71], v[22:23], v[180:181]
    v_pk_add_f32 v[56:57], v[56:57], 1.0 op_sel_hi:[1,0]
    v_pk_add_f32 v[58:59], v[58:59], 1.0 op_sel_hi:[1,0]
    v_pk_add_f32 v[60:61], v[60:61], 1.0 op_sel_hi:[1,0]
    v_pk_add_f32 v[62:63], v[62:63], 1.0 op_sel_hi:[1,0]
    v_rcp_f32 v56, v56
    v_rcp_f32 v57, v57
    v_rcp_f32 v58, v58
    v_rcp_f32 v59, v59
    v_rcp_f32 v60, v60
    v_rcp_f32 v61, v61
    v_rcp_f32 v62, v62
    v_rcp_f32 v63, v63
    v_pk_fma_f32 v[92:93], v[56:57], v[64:65], v[92:93]
    v_pk_fma_f32 v[94:95], v[60:61], v[68:69], v[94:95]
    v_pk_fma_f32 v[92:93], v[58:59], v[66:67], v[92:93]
    v_pk_fma_f32 v[94:95], v[62:63], v[70:71], v[94:95]
    v_pk_mul_f32 v[56:57], v[24:25], v[24:25]
    v_pk_mul_f32 v[58:59], v[26:27], v[26:27]
    v_pk_mul_f32 v[60:61], v[28:29], v[28:29]
    v_pk_mul_f32 v[62:63], v[30:31], v[30:31]
    v_pk_fma_f32 v[56:57], v[56:57], v[72:73], v[74:75]
    v_pk_fma_f32 v[58:59], v[58:59], v[72:73], v[74:75]
    v_pk_fma_f32 v[60:61], v[60:61], v[72:73], v[74:75]
    v_pk_fma_f32 v[62:63], v[62:63], v[72:73], v[74:75]
    v_pk_mul_f32 v[56:57], v[56:57], v[24:25]
    v_pk_mul_f32 v[58:59], v[58:59], v[26:27]
    v_pk_mul_f32 v[60:61], v[60:61], v[28:29]
    v_pk_mul_f32 v[62:63], v[62:63], v[30:31]
    v_exp_f32 v56, v56
    v_exp_f32 v57, v57
    v_exp_f32 v58, v58
    v_exp_f32 v59, v59
    v_exp_f32 v60, v60
    v_exp_f32 v61, v61
    v_exp_f32 v62, v62
    v_exp_f32 v63, v63
    v_pk_mul_f32 v[64:65], v[24:25], v[182:183]
    v_pk_mul_f32 v[66:67], v[26:27], v[184:185]
    v_pk_mul_f32 v[68:69], v[28:29], v[182:183]
    v_pk_mul_f32 v[70:71], v[30:31], v[184:185]
    v_pk_add_f32 v[56:57], v[56:57], 1.0 op_sel_hi:[1,0]
    v_pk_add_f32 v[58:59], v[58:59], 1.0 op_sel_hi:[1,0]
    v_pk_add_f32 v[60:61], v[60:61], 1.0 op_sel_hi:[1,0]
    v_pk_add_f32 v[62:63], v[62:63], 1.0 op_sel_hi:[1,0]
    v_rcp_f32 v56, v56
    v_rcp_f32 v57, v57
    v_rcp_f32 v58, v58
    v_rcp_f32 v59, v59
    v_rcp_f32 v60, v60
    v_rcp_f32 v61, v61
    v_rcp_f32 v62, v62
    v_rcp_f32 v63, v63
    v_pk_fma_f32 v[92:93], v[56:57], v[64:65], v[92:93]
    v_pk_fma_f32 v[94:95], v[60:61], v[68:69], v[94:95]
    v_pk_fma_f32 v[92:93], v[58:59], v[66:67], v[92:93]
    v_pk_fma_f32 v[94:95], v[62:63], v[70:71], v[94:95]
    v_pk_mul_f32 v[56:57], v[32:33], v[32:33]
    v_pk_mul_f32 v[58:59], v[34:35], v[34:35]
    v_pk_mul_f32 v[60:61], v[36:37], v[36:37]
    v_pk_mul_f32 v[62:63], v[38:39], v[38:39]
    v_pk_fma_f32 v[56:57], v[56:57], v[72:73], v[74:75]
    v_pk_fma_f32 v[58:59], v[58:59], v[72:73], v[74:75]
    v_pk_fma_f32 v[60:61], v[60:61], v[72:73], v[74:75]
    v_pk_fma_f32 v[62:63], v[62:63], v[72:73], v[74:75]
    v_pk_mul_f32 v[56:57], v[56:57], v[32:33]
    v_pk_mul_f32 v[58:59], v[58:59], v[34:35]
    v_pk_mul_f32 v[60:61], v[60:61], v[36:37]
    v_pk_mul_f32 v[62:63], v[62:63], v[38:39]
    v_exp_f32 v56, v56
    v_exp_f32 v57, v57
    v_exp_f32 v58, v58
    v_exp_f32 v59, v59
    v_exp_f32 v60, v60
    v_exp_f32 v61, v61
    v_exp_f32 v62, v62
    v_exp_f32 v63, v63
    v_pk_mul_f32 v[64:65], v[32:33], v[186:187]
    v_pk_mul_f32 v[66:67], v[34:35], v[188:189]
    v_pk_mul_f32 v[68:69], v[36:37], v[186:187]
    v_pk_mul_f32 v[70:71], v[38:39], v[188:189]
    v_pk_add_f32 v[56:57], v[56:57], 1.0 op_sel_hi:[1,0]
    v_pk_add_f32 v[58:59], v[58:59], 1.0 op_sel_hi:[1,0]
    v_pk_add_f32 v[60:61], v[60:61], 1.0 op_sel_hi:[1,0]
    v_pk_add_f32 v[62:63], v[62:63], 1.0 op_sel_hi:[1,0]
    v_rcp_f32 v56, v56
    v_rcp_f32 v57, v57
    v_rcp_f32 v58, v58
    v_rcp_f32 v59, v59
    v_rcp_f32 v60, v60
    v_rcp_f32 v61, v61
    v_rcp_f32 v62, v62
    v_rcp_f32 v63, v63
    v_pk_fma_f32 v[92:93], v[56:57], v[64:65], v[92:93]
    v_pk_fma_f32 v[94:95], v[60:61], v[68:69], v[94:95]
    v_pk_fma_f32 v[92:93], v[58:59], v[66:67], v[92:93]
    v_pk_fma_f32 v[94:95], v[62:63], v[70:71], v[94:95]
    v_pk_mul_f32 v[56:57], v[40:41], v[40:41]
    v_pk_mul_f32 v[58:59], v[42:43], v[42:43]
    v_pk_mul_f32 v[60:61], v[44:45], v[44:45]
    v_pk_mul_f32 v[62:63], v[46:47], v[46:47]
    v_pk_fma_f32 v[56:57], v[56:57], v[72:73], v[74:75]
    v_pk_fma_f32 v[58:59], v[58:59], v[72:73], v[74:75]
    v_pk_fma_f32 v[60:61], v[60:61], v[72:73], v[74:75]
    v_pk_fma_f32 v[62:63], v[62:63], v[72:73], v[74:75]
    v_pk_mul_f32 v[56:57], v[56:57], v[40:41]
    v_pk_mul_f32 v[58:59], v[58:59], v[42:43]
    v_pk_mul_f32 v[60:61], v[60:61], v[44:45]
    v_pk_mul_f32 v[62:63], v[62:63], v[46:47]
    v_exp_f32 v56, v56
    v_exp_f32 v57, v57
    v_exp_f32 v58, v58
    v_exp_f32 v59, v59
    v_exp_f32 v60, v60
    v_exp_f32 v61, v61
    v_exp_f32 v62, v62
    v_exp_f32 v63, v63
    v_pk_mul_f32 v[64:65], v[40:41], v[190:191]
    v_pk_mul_f32 v[66:67], v[42:43], v[192:193]
    v_pk_mul_f32 v[68:69], v[44:45], v[190:191]
    v_pk_mul_f32 v[70:71], v[46:47], v[192:193]
    v_pk_add_f32 v[56:57], v[56:57], 1.0 op_sel_hi:[1,0]
    v_pk_add_f32 v[58:59], v[58:59], 1.0 op_sel_hi:[1,0]
    v_pk_add_f32 v[60:61], v[60:61], 1.0 op_sel_hi:[1,0]
    v_pk_add_f32 v[62:63], v[62:63], 1.0 op_sel_hi:[1,0]
    v_rcp_f32 v56, v56
    v_rcp_f32 v57, v57
    v_rcp_f32 v58, v58
    v_rcp_f32 v59, v59
    v_rcp_f32 v60, v60
    v_rcp_f32 v61, v61
    v_rcp_f32 v62, v62
    v_rcp_f32 v63, v63
    v_pk_fma_f32 v[92:93], v[56:57], v[64:65], v[92:93]
    v_pk_fma_f32 v[94:95], v[60:61], v[68:69], v[94:95]
    v_pk_fma_f32 v[92:93], v[58:59], v[66:67], v[92:93]
    v_pk_fma_f32 v[94:95], v[62:63], v[70:71], v[94:95]
    s_cmp_ge_u32 s42, 4
    s_cbranch_scc1 L_gelu6
    v_pk_mul_f32 v[56:57], v[48:49], v[48:49]
    v_pk_mul_f32 v[58:59], v[50:51], v[50:51]
    v_pk_mul_f32 v[60:61], v[52:53], v[52:53]
    v_pk_mul_f32 v[62:63], v[54:55], v[54:55]
    v_pk_fma_f32 v[56:57], v[56:57], v[72:73], v[74:75]
    v_pk_fma_f32 v[58:59], v[58:59], v[72:73], v[74:75]
    v_pk_fma_f32 v[60:61], v[60:61], v[72:73], v[74:75]
    v_pk_fma_f32 v[62:63], v[62:63], v[72:73], v[74:75]
    v_pk_mul_f32 v[56:57], v[56:57], v[48:49]
    v_pk_mul_f32 v[58:59], v[58:59], v[50:51]
    v_pk_mul_f32 v[60:61], v[60:61], v[52:53]
    v_pk_mul_f32 v[62:63], v[62:63], v[54:55]
    v_exp_f32 v56, v56
    v_exp_f32 v57, v57
    v_exp_f32 v58, v58
    v_exp_f32 v59, v59
    v_exp_f32 v60, v60
    v_exp_f32 v61, v61
    v_exp_f32 v62, v62
    v_exp_f32 v63, v63
    v_pk_mul_f32 v[64:65], v[48:49], v[194:195]
    v_pk_mul_f32 v[66:67], v[50:51], v[196:197]
    v_pk_mul_f32 v[68:69], v[52:53], v[194:195]
    v_pk_mul_f32 v[70:71], v[54:55], v[196:197]
    v_pk_add_f32 v[56:57], v[56:57], 1.0 op_sel_hi:[1,0]
    v_pk_add_f32 v[58:59], v[58:59], 1.0 op_sel_hi:[1,0]
    v_pk_add_f32 v[60:61], v[60:61], 1.0 op_sel_hi:[1,0]
    v_pk_add_f32 v[62:63], v[62:63], 1.0 op_sel_hi:[1,0]
    v_rcp_f32 v56, v56
    v_rcp_f32 v57, v57
    v_rcp_f32 v58, v58
    v_rcp_f32 v59, v59
    v_rcp_f32 v60, v60
    v_rcp_f32 v61, v61
    v_rcp_f32 v62, v62
    v_rcp_f32 v63, v63
    v_pk_fma_f32 v[92:93], v[56:57], v[64:65], v[92:93]
    v_pk_fma_f32 v[94:95], v[60:61], v[68:69], v[94:95]
    v_pk_fma_f32 v[92:93], v[58:59], v[66:67], v[92:93]
    v_pk_fma_f32 v[94:95], v[62:63], v[70:71], v[94:95]
L_gelu6:
    v_add_f32 v92, v92, v93
    v_add_f32 v94, v94, v95
    v_and_b32 v84, 15, v137
    v_lshrrev_b32 v85, 5, v137
    v_permlane32_swap_b32 v92, v94
    v_lshl_add_u32 v84, v85, 4, v84
    v_add_f32 v92, v92, v94
    v_bfe_u32 v85, v137, 4, 1
    v_mov_b32 v93, v92
    v_lshlrev_b32 v84, 2, v84
    v_lshl_add_u32 v84, v85, 30, v84
    v_permlane16_swap_b32 v92, v93
    s_lshl2_add_u32 s52, s43, s44
    v_add_f32 v92, v92, v93
    s_lshl3_add_u32 s52, s52, s42
    s_lshl_b32 s52, s52, 7
    v_min_u32 v92, -2, v92
L_dflag:
    s_waitcnt vmcnt(0)
    v_readfirstlane_b32 s51, v99
    s_cmp_ge_u32 s51, 26
    s_cbranch_scc1 L_pub
    global_load_dword v99, v98, s[38:39] offset:64 sc1
    s_sleep 4
    s_sub_u32 s50, s50, 1
    s_cbranch_scc0 L_dflag
    s_endpgm
L_pub:
    s_add_u32 s53, s52, 0x20000
    buffer_store_dword v92, v84, s[32:35], s53 offen
    buffer_store_dword v92, v84, s[32:35], s52 offen sc1
    s_endpgm
.p2align 6
.type gather_table,@object
gather_table:
.short 38912, 45568, 39056, 38916, 39200, 38920, 39488, 38928, 39208, 45568, 39632, 38932, 39352, 39212, 39776, 38936
.short 39060, 45568, 39204, 39064, 39348, 39068, 39636, 39076, 39356, 45568, 39780, 39080, 38924, 39344, 39924, 39084
.short 39496, 39216, 39920, 38940, 39640, 39220, 40064, 38944, 39784, 39224, 39504, 45568, 40208, 38948, 39928, 39228
.short 39644, 39364, 39492, 39072, 39788, 39368, 40212, 39092, 39932, 39372, 39652, 45568, 40356, 39096, 39500, 39360
.short 39648, 39508, 40352, 38952, 40072, 39232, 39792, 39512, 40496, 38956, 40216, 39236, 40640, 38960, 40360, 39240
.short 39796, 39656, 40500, 39100, 40220, 39380, 39940, 39660, 40068, 39088, 40364, 39384, 40788, 39108, 40508, 39388
.short 40080, 39520, 39800, 45568, 40784, 38964, 40504, 39244, 40224, 39524, 39944, 39804, 40928, 38968, 40648, 39248
.short 40228, 39668, 39948, 45568, 40932, 39112, 40076, 39376, 40372, 39672, 39516, 39936, 41076, 39116, 40796, 39396
.short 40368, 39528, 40088, 39808, 41072, 38972, 40792, 39252, 40512, 39532, 40232, 39812, 41216, 38976, 40936, 39256
.short 40516, 39676, 40236, 39956, 40644, 39104, 40940, 39400, 40084, 39664, 40380, 39960, 41364, 39124, 41084, 39404
.short 40656, 39536, 40376, 39816, 40096, 45568, 41360, 38980, 41080, 39260, 40800, 39540, 40520, 39820, 40240, 40100
.short 40804, 39684, 40524, 39964, 40244, 45568, 41508, 39128, 40652, 39392, 40948, 39688, 40092, 39952, 40388, 40248
.short 41504, 38984, 41224, 39264, 40944, 39544, 40664, 39824, 40384, 40104, 41648, 38988, 41368, 39268, 41088, 39548
.short 41652, 39132, 41372, 39412, 41092, 39692, 40812, 39972, 40532, 40252, 41220, 39120, 41516, 39416, 40660, 39680
.short 40808, 39828, 41792, 38992, 41512, 39272, 41232, 39552, 40952, 39832, 40672, 40112, 40392, 45568, 41936, 38996
.short 40956, 39976, 41940, 39140, 41660, 39420, 41380, 39700, 41100, 39980, 40820, 40260, 40540, 45568, 42084, 39144
.short 41656, 39276, 41376, 39556, 41096, 39836, 40816, 40116, 40536, 40396, 42080, 39000, 41800, 39280, 41520, 39560
.short 41228, 39408, 41524, 39704, 40668, 39968, 40964, 40264, 40108, 40528, 42228, 39148, 41948, 39428, 41668, 39708
.short 41240, 39840, 40960, 40120, 40680, 40400, 42224, 39004, 41944, 39284, 41664, 39564, 41384, 39844, 41104, 40124
.short 41388, 39988, 41108, 40268, 40828, 40548, 41796, 39136, 42092, 39432, 41236, 39696, 41532, 39992, 40676, 40256
.short 40824, 40404, 42368, 39008, 42088, 39288, 41808, 39568, 41528, 39848, 41248, 40128, 40968, 40408, 40688, 45568
.short 40972, 40552, 42516, 39156, 42236, 39436, 41956, 39716, 41676, 39996, 41396, 40276, 41116, 40556, 40836, 45568
.short 42512, 39012, 42232, 39292, 41952, 39572, 41672, 39852, 41392, 40132, 41112, 40412, 40832, 40692, 42376, 39296
.short 42372, 39152, 41804, 39424, 42100, 39720, 41244, 39984, 41540, 40280, 40684, 40544, 40980, 40840, 42524, 39444
.short 42096, 39576, 41816, 39856, 41536, 40136, 41256, 40416, 40976, 40696, 42520, 39300, 42240, 39580, 41960, 39860
.short 42244, 39724, 41964, 40004, 41684, 40284, 41404, 40564, 41124, 40844, 42380, 39440, 41812, 39712, 42108, 40008
.short 41680, 40140, 41400, 40420, 42384, 39584, 42104, 39864, 41824, 40144, 41544, 40424, 41264, 40704, 40984, 45568
.short 41252, 40272, 41548, 40568, 42532, 39732, 42252, 40012, 41972, 40292, 41692, 40572, 41412, 40852, 41132, 45568
.short 42528, 39588, 42248, 39868, 41968, 40148, 41688, 40428, 41408, 40708, 41128, 40988, 42392, 39872, 42112, 40152
.short 42388, 39728, 41820, 40000, 42116, 40296, 41260, 40560, 41556, 40856, 40700, 41120, 42540, 40020, 42260, 40300
.short 41832, 40432, 41552, 40712, 41272, 40992, 42536, 39876, 42256, 40156, 41976, 40436, 41696, 40716, 41416, 40996
.short 41980, 40580, 41700, 40860, 41420, 41140, 42396, 40016, 41828, 40288, 42124, 40584, 41268, 40848, 41564, 41144
.short 42400, 40160, 42120, 40440, 41840, 40720, 41560, 41000, 41280, 45568, 42544, 40164, 42264, 40444, 41984, 40724
.short 42548, 40308, 42268, 40588, 41988, 40868, 41708, 41148, 41428, 45568, 42404, 40304, 41836, 40576, 42132, 40872
.short 41704, 41004, 41424, 41284, 42408, 40448, 42128, 40728, 41848, 41008, 41568, 41288, 42552, 40452, 42272, 40732
.short 41276, 41136, 41572, 41432, 42556, 40596, 42276, 40876, 41996, 41156, 41716, 41436, 42412, 40592, 41844, 40864
.short 41992, 41012, 42416, 40736, 42136, 41016, 41856, 41296, 41576, 45568, 42560, 40740, 42280, 41020, 42000, 41300
.short 42140, 41160, 42564, 40884, 42284, 41164, 42004, 41444, 41724, 45568, 42420, 40880, 41852, 41152, 42148, 41448
.short 41720, 41580, 42424, 41024, 42144, 41304, 41864, 41584, 42568, 41028, 42288, 41308, 42008, 41588, 42432, 41312
.short 41292, 41712, 42572, 41172, 42292, 41452, 42012, 41732, 42428, 41168, 41860, 41440, 42156, 41736, 42580, 41460
.short 42152, 41592, 41872, 45568, 42576, 41316, 42296, 41596, 42016, 41876, 42440, 41600, 42160, 41880, 42584, 41604
.short 42300, 41740, 42020, 45568, 42436, 41456, 41868, 41728, 42164, 42024, 42588, 41748, 42308, 42028, 42444, 41744
.short 42448, 41888, 42168, 45568, 42592, 41892, 42312, 42172, 42456, 42176, 42600, 42180, 42464, 45568, 42608, 45568
.short 42596, 42036, 42316, 45568, 42452, 42032, 41884, 42304, 42604, 42324, 42460, 42320, 42612, 45568, 42468, 45568
.short 42656, 45568, 42664, 45568, 42672, 45568, 42680, 45568, 42688, 45568, 42696, 45568, 42704, 45568, 42712, 45568
.short 42660, 45568, 42668, 45568, 42676, 45568, 42684, 45568, 42692, 45568, 42700, 45568, 42708, 45568, 42716, 45568
.short 42720, 45568, 42728, 45568, 42736, 45568, 42744, 45568, 42752, 45568, 45696, 45568, 45568, 45568, 45568, 45568
.short 42724, 45568, 42732, 45568, 42740, 45568, 42748, 45568, 42756, 45568, 45568, 45568, 45568, 45568, 45568, 45568
.short 45568, 45568, 45568, 45568, 45568, 45568, 45568, 45568, 45568, 45568, 45568, 45568, 45568, 45568, 45568, 45568
.short 45568, 45568, 45568, 45568, 45568, 45568, 45568, 45568, 45568, 45568, 45568, 45568, 45568, 45568, 45568, 45568
.short 45568, 45568, 45568, 45568, 45568, 45568, 45568, 45568, 45568, 45568, 45568, 45568, 45568, 45568, 45568, 45568
.short 45568, 45568, 45568, 45568, 45568, 45568, 45568, 45568, 45568, 45568, 45568, 45568, 45568, 45568, 45568, 45568
.short 45568, 45568, 45568, 45568, 45568, 45568, 45568, 45568, 45568, 45568, 45568, 45568, 45568, 45568, 45568, 45568
.short 45568, 45568, 45568, 45568, 45568, 45568, 45568, 45568, 45568, 45568, 45568, 45568, 45568, 45568, 45568, 45568
.short 45568, 45568, 45568, 45568, 45568, 45568, 45568, 45568, 45568, 45568, 45568, 45568, 45568, 45568, 45568, 45568
.short 45568, 45568, 45568, 45568, 45568, 45568, 45568, 45568, 45568, 45568, 45568, 45568, 45568, 45568, 45568, 45568
.short 45568, 45568, 45568, 45568, 45568, 45568, 45568, 45568, 45568, 45568, 45568, 45568, 45568, 45568, 45568, 45568
.short 45568, 45568, 45568, 45568, 45568, 45568, 45568, 45568, 45568, 45568, 45568, 45568, 45568, 45568, 45568, 45568
.short 45568, 45568, 45568, 45568, 45568, 45568, 45568, 45568, 45568, 45568, 45568, 45568, 45568, 45568, 45568, 45568
.short 45568, 45568, 45568, 45568, 45568, 45568, 45568, 45568, 45568, 45568, 45568, 45568, 45568, 45568, 45568, 45568
.short 45568, 45568, 45568, 45568, 45568, 45568, 45568, 45568, 45568, 45568, 45568, 45568, 45568, 45568, 45568, 45568
.short 45568, 45568, 45568, 45568, 45568, 45568, 45568, 45568, 45568, 45568, 45568, 45568, 45568, 45568, 45568, 45568
.short 45568, 45568, 45568, 45568, 45568, 45568, 45568, 45568, 45568, 45568, 45568, 45568, 45568, 45568, 45568, 45568
.short 45568, 45568, 45568, 45568, 45568, 45568, 45568, 45568, 45568, 45568, 45568, 45568, 45568, 45568, 45568, 45568
.short 43520, 45568, 43522, 43572, 43524, 43624, 43528, 43728, 43628, 45568, 43530, 43780, 43630, 43680, 43532, 43832
.short 43574, 45568, 43576, 43626, 43578, 43678, 43582, 43782, 43682, 45568, 43584, 43834, 43676, 43526, 43586, 43886
.short 43632, 43732, 43534, 43884, 43634, 43784, 43536, 43936, 43636, 43836, 43736, 45568, 43538, 43988, 43638, 43888
.short 43686, 43786, 43580, 43730, 43688, 43838, 43590, 43990, 43690, 43890, 43790, 45568, 43592, 44042, 43684, 43734
.short 43738, 43788, 43540, 44040, 43640, 43940, 43740, 43840, 43542, 44092, 43642, 43992, 43544, 44144, 43644, 44044
.short 43792, 43842, 43594, 44094, 43694, 43994, 43794, 43894, 43588, 43938, 43696, 44046, 43598, 44198, 43698, 44098
.short 43744, 43944, 43844, 45568, 43546, 44196, 43646, 44096, 43746, 43996, 43846, 43896, 43548, 44248, 43648, 44148
.short 43798, 43998, 43898, 45568, 43600, 44250, 43692, 43942, 43800, 44050, 43892, 43742, 43602, 44302, 43702, 44202
.short 43748, 44048, 43848, 43948, 43550, 44300, 43650, 44200, 43750, 44100, 43850, 44000, 43552, 44352, 43652, 44252
.short 43802, 44102, 43902, 44002, 43596, 44146, 43704, 44254, 43796, 43946, 43904, 44054, 43606, 44406, 43706, 44306
.short 43752, 44152, 43852, 44052, 43952, 45568, 43554, 44404, 43654, 44304, 43754, 44204, 43854, 44104, 43954, 44004
.short 43806, 44206, 43906, 44106, 44006, 45568, 43608, 44458, 43700, 44150, 43808, 44258, 43900, 43950, 44008, 44058
.short 43556, 44456, 43656, 44356, 43756, 44256, 43856, 44156, 43956, 44056, 43558, 44508, 43658, 44408, 43758, 44308
.short 43610, 44510, 43710, 44410, 43810, 44310, 43910, 44210, 44010, 44110, 43604, 44354, 43712, 44462, 43804, 44154
.short 43858, 44208, 43560, 44560, 43660, 44460, 43760, 44360, 43860, 44260, 43960, 44160, 44060, 45568, 43562, 44612
.short 43912, 44262, 43614, 44614, 43714, 44514, 43814, 44414, 43914, 44314, 44014, 44214, 44114, 45568, 43616, 44666
.short 43662, 44512, 43762, 44412, 43862, 44312, 43962, 44212, 44062, 44112, 43564, 44664, 43664, 44564, 43764, 44464
.short 43708, 44358, 43816, 44466, 43908, 44158, 44016, 44266, 44108, 43958, 43618, 44718, 43718, 44618, 43818, 44518
.short 43864, 44364, 43964, 44264, 44064, 44164, 43566, 44716, 43666, 44616, 43766, 44516, 43866, 44416, 43966, 44316
.short 43918, 44418, 44018, 44318, 44118, 44218, 43612, 44562, 43720, 44670, 43812, 44362, 43920, 44470, 44012, 44162
.short 44066, 44216, 43568, 44768, 43668, 44668, 43768, 44568, 43868, 44468, 43968, 44368, 44068, 44268, 44168, 45568
.short 44120, 44270, 43622, 44822, 43722, 44722, 43822, 44622, 43922, 44522, 44022, 44422, 44122, 44322, 44222, 45568
.short 43570, 44820, 43670, 44720, 43770, 44620, 43870, 44520, 43970, 44420, 44070, 44320, 44170, 44220, 43672, 44772
.short 43620, 44770, 43716, 44566, 43824, 44674, 43916, 44366, 44024, 44474, 44116, 44166, 44224, 44274, 43726, 44826
.short 43772, 44672, 43872, 44572, 43972, 44472, 44072, 44372, 44172, 44272, 43674, 44824, 43774, 44724, 43874, 44624
.short 43826, 44726, 43926, 44626, 44026, 44526, 44126, 44426, 44226, 44326, 43724, 44774, 43820, 44570, 43928, 44678
.short 43974, 44524, 44074, 44424, 43776, 44776, 43876, 44676, 43976, 44576, 44076, 44476, 44176, 44376, 44276, 45568
.short 44020, 44370, 44128, 44478, 43830, 44830, 43930, 44730, 44030, 44630, 44130, 44530, 44230, 44430, 44330, 45568
.short 43778, 44828, 43878, 44728, 43978, 44628, 44078, 44528, 44178, 44428, 44278, 44328, 43880, 44780, 43980, 44680
.short 43828, 44778, 43924, 44574, 44032, 44682, 44124, 44374, 44232, 44482, 44324, 44174, 43934, 44834, 44034, 44734
.short 44080, 44580, 44180, 44480, 44280, 44380, 43882, 44832, 43982, 44732, 44082, 44632, 44182, 44532, 44282, 44432
.short 44134, 44634, 44234, 44534, 44334, 44434, 43932, 44782, 44028, 44578, 44136, 44686, 44228, 44378, 44336, 44486
.short 43984, 44784, 44084, 44684, 44184, 44584, 44284, 44484, 44384, 45568, 43986, 44836, 44086, 44736, 44186, 44636
.short 44038, 44838, 44138, 44738, 44238, 44638, 44338, 44538, 44438, 45568, 44036, 44786, 44132, 44582, 44240, 44690
.short 44286, 44536, 44386, 44436, 44088, 44788, 44188, 44688, 44288, 44588, 44388, 44488, 44090, 44840, 44190, 44740
.short 44332, 44382, 44440, 44490, 44142, 44842, 44242, 44742, 44342, 44642, 44442, 44542, 44140, 44790, 44236, 44586
.short 44290, 44640, 44192, 44792, 44292, 44692, 44392, 44592, 44492, 45568, 44194, 44844, 44294, 44744, 44394, 44644
.short 44344, 44694, 44246, 44846, 44346, 44746, 44446, 44646, 44546, 45568, 44244, 44794, 44340, 44590, 44448, 44698
.short 44494, 44544, 44296, 44796, 44396, 44696, 44496, 44596, 44298, 44848, 44398, 44748, 44498, 44648, 44400, 44800
.short 44540, 44390, 44350, 44850, 44450, 44750, 44550, 44650, 44348, 44798, 44444, 44594, 44552, 44702, 44454, 44854
.short 44500, 44700, 44600, 45568, 44402, 44852, 44502, 44752, 44602, 44652, 44504, 44804, 44604, 44704, 44506, 44856
.short 44554, 44754, 44654, 45568, 44452, 44802, 44548, 44598, 44656, 44706, 44558, 44858, 44658, 44758, 44556, 44806
.short 44608, 44808, 44708, 45568, 44610, 44860, 44710, 44760, 44712, 44812, 44714, 44864, 44816, 45568, 44818, 45568
.short 44662, 44862, 44762, 45568, 44660, 44810, 44756, 44606, 44766, 44866, 44764, 44814, 44870, 45568, 44868, 45568
.short 45568, 45568, 45568, 45568, 45568, 45568, 45568, 45568, 45568, 45568, 45568, 45568, 45568, 45568, 45568, 45568
.short 45568, 45568, 45568, 45568, 45568, 45568, 45568, 45568, 45568, 45568, 45568, 45568, 45568, 45568, 45568, 45568
.short 45568, 45568, 45568, 45568, 45568, 45568, 45568, 45568, 45568, 45568, 45568, 45568, 45568, 45568, 45568, 45568
.short 45568, 45568, 45568, 45568, 45568, 45568, 45568, 45568, 45568, 45568, 45568, 45568, 45568, 45568, 45568, 45568
.short 45568, 45568, 45568, 45568, 45568, 45568, 45568, 45568, 45568, 45568, 45568, 45568, 45568, 45568, 45568, 45568
.short 45568, 45568, 45568, 45568, 45568, 45568, 45568, 45568, 45568, 45568, 45568, 45568, 45568, 45568, 45568, 45568
.short 45568, 45568, 45568, 45568, 45568, 45568, 45568, 45568, 45568, 45568, 45568, 45568, 45568, 45568, 45568, 45568
.short 45568, 45568, 45568, 45568, 45568, 45568, 45568, 45568, 45568, 45568, 45568, 45568, 45568, 45568, 45568, 45568
.short 45568, 45568, 45568, 45568, 45568, 45568, 45568, 45568, 45568, 45568, 45568, 45568, 45568, 45568, 45568, 45568
.short 45568, 45568, 45568, 45568, 45568, 45568, 45568, 45568, 45568, 45568, 45568, 45568, 45568, 45568, 45568, 45568
.short 45568, 45568, 45568, 45568, 45568, 45568, 45568, 45568, 45568, 45568, 45568, 45568, 45568, 45568, 45568, 45568
.short 45568, 45568, 45568, 45568, 45568, 45568, 45568, 45568, 45568, 45568, 45568, 45568, 45568, 45568, 45568, 45568
.short 45568, 45568, 45568, 45568, 45568, 45568, 45568, 45568, 45568, 45568, 45568, 45568, 45568, 45568, 45568, 45568
.short 45568, 45568, 45568, 45568, 45568, 45568, 45568, 45568, 45568, 45568, 45568, 45568, 45568, 45568, 45568, 45568
.short 45568, 45568, 45568, 45568, 45568, 45568, 45568, 45568, 45568, 45568, 45568, 45568, 45568, 45568, 45568, 45568
.short 45568, 45568, 45568, 45568, 45568, 45568, 45568, 45568, 45568, 45568, 45568, 45568, 45568, 45568, 45568, 45568
.short 45568, 45568, 45568, 45568, 45568, 45568, 45568, 45568, 45568, 45568, 45568, 45568, 45568, 45568, 45568, 45568
.short 45568, 45568, 45568, 45568, 45568, 45568, 45568, 45568, 45568, 45568, 45568, 45568, 45568, 45568, 45568, 45568
.short 45568, 45568, 45568, 45568, 45568, 45568, 45568, 45568, 45568, 45568, 45568, 45568, 45568, 45568, 45568, 45568
.short 45568, 45568, 45568, 45568, 45568, 45568, 45568, 45568, 45568, 45568, 45568, 45568, 45568, 45568, 45568, 45568
.size gather_table, 4096
.section .rodata,"a"
.p2align 6
.amdhsa_kernel standalone__deep_cross_xdeepfm__recsys_kernel
  .amdhsa_next_free_vgpr 256
  .amdhsa_next_free_sgpr 102
  .amdhsa_accum_offset 256
  .amdhsa_group_segment_fixed_size 0
  .amdhsa_kernarg_size 88
  .amdhsa_user_sgpr_count 2
  .amdhsa_user_sgpr_kernarg_segment_ptr 1
  .amdhsa_system_sgpr_workgroup_id_x 1
  .amdhsa_float_denorm_mode_32 3
.end_amdhsa_kernel
```
